```python
import torch

def _softmax(x, axis=-1):
    return torch.softmax(x, dim=axis)
def _gelu(x):
    return torch.nn.functional.gelu(x, approximate="tanh")
def _silu(x):
    return torch.nn.functional.silu(x)
def _sigmoid(x):
    return torch.sigmoid(x)
def _layernorm(x, axis=-1, eps=1e-5):
    m = x.mean(dim=axis, keepdim=True)
    v = x.var(dim=axis, keepdim=True, unbiased=False)
    return (x - m) / torch.sqrt(v + eps)
def _scatter_add(tgt, idx, src, axis=0):
    return tgt.clone().index_add_(axis, idx, src)
def _segment_sum(src, seg, n):
    out = torch.zeros((n,) + src.shape[1:], dtype=src.dtype)
    return out.index_add_(0, seg, src)
def _pad(x, pw):
    flat = tuple(v for pair in reversed(pw) for v in pair)
    return torch.nn.functional.pad(x, flat)

kernel_name = 'sequential_preLN__softmax_full_mha__dense_activation_gelu__prompt'

def setup_inputs():

    _w = (lambda a: (lambda t: t.to(torch.bfloat16) if t.is_floating_point() else t)(torch.as_tensor(a)))
    def _A_setup():
        B, S, D = 1, 2048, 512
        return {
            "x": _w((lambda *s: torch.randn(*s, dtype=torch.bfloat16) * 0.05)(B, S, D)),
            "wqkv": _w((lambda *s: torch.randn(*s, dtype=torch.bfloat16) * 0.05)(D, 3 * D)),
            "wo": _w((lambda *s: torch.randn(*s, dtype=torch.bfloat16) * 0.05)(D, D)),
        }
    _A_in = _A_setup()

    def _B_setup():
        B, S, D, F = 1, 2048, 512, 1792
        return {
            "x": _w((lambda *s: torch.randn(*s, dtype=torch.bfloat16) * 0.05)(B, S, D)),
            "w1": _w((lambda *s: torch.randn(*s, dtype=torch.bfloat16) * 0.8)(D, F) * (D ** -0.5)),
            "b1": _w((lambda *s: torch.randn(*s, dtype=torch.bfloat16) * 0.2)(F) * 0.01),
            "w2": _w((lambda *s: torch.randn(*s, dtype=torch.bfloat16) * 0.2)(F, D) * (F ** -0.5)),
            "b2": _w((lambda *s: torch.randn(*s, dtype=torch.bfloat16) * 0.2)(D) * 0.01),
        }
    _B_in = _B_setup()

    return {
        "A_x": _A_in["x"],
        "A_wqkv": _A_in["wqkv"],
        "A_wo": _A_in["wo"],
        "B_x": _B_in["x"],
        "B_w1": _B_in["w1"],
        "B_b1": _B_in["b1"],
        "B_w2": _B_in["w2"],
        "B_b2": _B_in["b2"],
    }

def reference(A_x, A_wqkv, A_wo, B_x, B_w1, B_b1, B_w2, B_b2):
    def _A_ref(x, wqkv, wo):
        B, S, D = x.shape
        H = 32; Dh = D // H
        qkv = (lambda x, *d: x.permute(*d))((x @ wqkv).reshape(B, S, 3, H, Dh), 2, 0, 3, 1, 4)
        q, k, v = qkv[0], qkv[1], qkv[2]
        scale = Dh ** -0.5
        scores = torch.einsum("bhqd,bhkd->bhqk", q, k) * scale
        p = _softmax(scores, axis=-1)
        o = torch.einsum("bhqk,bhkd->bhqd", p, v)
        return (lambda x, *d: x.permute(*d))(o, 0, 2, 1, 3).reshape(B, S, D) @ wo

    def _B_ref(x, w1, b1, w2, b2):
        h = torch.einsum("bsd,df->bsf", x, w1) + b1
        h = _gelu(h)
        return torch.einsum("bsf,fd->bsd", h, w2) + b2

    x = A_x
    h = x + _A_ref(_layernorm(x, axis=-1), A_wqkv, A_wo)
    h2 = h + _B_ref(_layernorm(h, axis=-1), B_w1, B_b1, B_w2, B_b2)
    return h2
```

```asm
; @launch grid=(256,1,1) block=(512,1,1) lds=163840
.amdgcn_target "amdgcn-amd-amdhsa--gfx950"
.text
.globl sequential_preLN__softmax_full_mha__dense_activation_gelu__prompt_kernel
.p2align 8
.type sequential_preLN__softmax_full_mha__dense_activation_gelu__prompt_kernel,@function
sequential_preLN__softmax_full_mha__dense_activation_gelu__prompt_kernel:

  s_cmp_ge_u32 s2, 256
  s_cbranch_scc1 E_exit
  s_load_dwordx16 s[64:79], s[0:1], 0
  s_load_dwordx4 s[80:83], s[0:1], 64
  s_load_dwordx2 s[84:85], s[0:1], 80
  v_lshrrev_b32 v2, 6, v0
  v_and_b32 v1, 63, v0
  v_readfirstlane_b32 s24, v2
  v_lshlrev_b32 v250, 2, v1
  v_and_b32 v250, 60, v250
  v_add_u32 v250, 163776, v250
  v_mov_b32 v251, 0
  ds_write_b32 v250, v251
  s_cmp_lg_u32 s2, 0
  s_cbranch_scc1 N_skip
  s_cmp_lg_u32 s24, 7
  s_cbranch_scc1 N_skip
  s_memrealtime s[96:97]
  s_waitcnt lgkmcnt(0)
  s_mov_b32 s8, s82
  s_and_b32 s9, s83, 0xffff
  s_mov_b32 s10, 256
  s_mov_b32 s11, 0x20000
  s_or_b32 s96, s96, 1
  v_mov_b32 v250, s96
  v_mov_b32 v251, 0
  s_mov_b64 exec, 1
  buffer_store_dword v250, v251, s[8:11], 0 offen sc1
  s_mov_b64 exec, -1
  s_waitcnt vmcnt(0)
N_skip:
  s_and_b32 s27, s2, 7
  s_lshr_b32 s28, s2, 3
  s_lshr_b32 s25, s27, 1
  s_lshl_b32 s25, s25, 3
  s_and_b32 s29, s28, 7
  s_add_u32 s25, s25, s29
  s_and_b32 s26, s27, 1
  s_lshl_b32 s26, s26, 2
  s_lshr_b32 s29, s28, 3
  s_add_u32 s26, s26, s29
  v_lshrrev_b32 v2, 3, v1
  v_and_b32 v3, 7, v1
  v_lshlrev_b32 v5, 10, v2
  v_lshl_add_u32 v5, v3, 4, v5
  s_lshl_b32 s32, s25, 6
  s_lshl_b32 s33, s24, 3
  s_add_u32 s32, s32, s33
  s_lshl_b32 s32, s32, 10
  s_waitcnt lgkmcnt(0)
  s_mov_b32 s8, s64
  s_and_b32 s9, s65, 0xffff
  s_mov_b32 s10, 2097152
  s_mov_b32 s11, 0x20000
  buffer_load_dwordx4 v[64:67], v5, s[8:11], s32 offen offset:0
  buffer_load_dwordx4 v[68:71], v5, s[8:11], s32 offen offset:128
  buffer_load_dwordx4 v[72:75], v5, s[8:11], s32 offen offset:256
  buffer_load_dwordx4 v[76:79], v5, s[8:11], s32 offen offset:384
  buffer_load_dwordx4 v[80:83], v5, s[8:11], s32 offen offset:512
  buffer_load_dwordx4 v[84:87], v5, s[8:11], s32 offen offset:640
  buffer_load_dwordx4 v[88:91], v5, s[8:11], s32 offen offset:768
  buffer_load_dwordx4 v[92:95], v5, s[8:11], s32 offen offset:896
  s_mov_b32 s12, s66
  s_and_b32 s13, s67, 0xffff
  s_mov_b32 s14, 1572864
  s_mov_b32 s15, 0x20000
  v_lshrrev_b32 v6, 3, v1
  s_mov_b32 s59, 3072
  v_mul_lo_u32 v4, v6, s59
  v_bfe_u32 v6, v1, 4, 1
  v_lshlrev_b32 v6, 2, v6
  v_and_b32 v7, 7, v1
  v_xor_b32 v6, v6, v7
  v_lshl_add_u32 v4, v6, 4, v4
  v_add_u32 v13, 23552, v4
  s_and_b32 s29, s24, 3
  s_mul_i32 s34, s29, 49152
  s_lshl_b32 s36, s26, 7
  s_add_u32 s34, s34, s36
  s_lshl_b32 s37, s29, 11
  s_lshl_b32 s33, s24, 3
  v_add_u32 v6, s33, v2
  v_and_b32 v7, 31, v6
  v_and_b32 v9, 4, v7
  v_and_b32 v10, 8, v7
  v_lshlrev_b32 v9, 1, v9
  v_lshrrev_b32 v10, 1, v10
  v_and_b32 v8, 0xfffffff3, v7
  v_or3_b32 v8, v8, v9, v10
  v_lshrrev_b32 v7, 5, v6
  v_mul_u32_u24 v7, 33792, v7
  v_lshl_add_u32 v7, v8, 4, v7
  v_lshrrev_b32 v8, 1, v3
  v_mul_u32_u24 v8, 1056, v8
  v_add_u32 v7, v7, v8
  v_and_b32 v8, 1, v3
  v_mul_u32_u24 v8, 528, v8
  v_add_u32 v12, v7, v8
  s_mov_b32 s35, 0x3f803f80
  s_cmp_ge_u32 s24, 4
  s_cbranch_scc1 P1_prod
  v_mov_b32 v8, 0
  v_mov_b32 v9, 0
  v_mov_b32 v10, 0
  v_mov_b32 v11, 0
  s_waitcnt vmcnt(6)
  v_dot2c_f32_bf16 v8, s35, v64
  v_dot2c_f32_bf16 v9, v64, v64
  v_dot2c_f32_bf16 v10, s35, v65
  v_dot2c_f32_bf16 v11, v65, v65
  v_dot2c_f32_bf16 v8, s35, v66
  v_dot2c_f32_bf16 v9, v66, v66
  v_dot2c_f32_bf16 v10, s35, v67
  v_dot2c_f32_bf16 v11, v67, v67
  v_dot2c_f32_bf16 v8, s35, v68
  v_dot2c_f32_bf16 v9, v68, v68
  v_dot2c_f32_bf16 v10, s35, v69
  v_dot2c_f32_bf16 v11, v69, v69
  v_dot2c_f32_bf16 v8, s35, v70
  v_dot2c_f32_bf16 v9, v70, v70
  v_dot2c_f32_bf16 v10, s35, v71
  v_dot2c_f32_bf16 v11, v71, v71
  s_waitcnt vmcnt(4)
  v_dot2c_f32_bf16 v8, s35, v72
  v_dot2c_f32_bf16 v9, v72, v72
  v_dot2c_f32_bf16 v10, s35, v73
  v_dot2c_f32_bf16 v11, v73, v73
  v_dot2c_f32_bf16 v8, s35, v74
  v_dot2c_f32_bf16 v9, v74, v74
  v_dot2c_f32_bf16 v10, s35, v75
  v_dot2c_f32_bf16 v11, v75, v75
  v_dot2c_f32_bf16 v8, s35, v76
  v_dot2c_f32_bf16 v9, v76, v76
  v_dot2c_f32_bf16 v10, s35, v77
  v_dot2c_f32_bf16 v11, v77, v77
  v_dot2c_f32_bf16 v8, s35, v78
  v_dot2c_f32_bf16 v9, v78, v78
  v_dot2c_f32_bf16 v10, s35, v79
  v_dot2c_f32_bf16 v11, v79, v79
  s_waitcnt vmcnt(2)
  v_dot2c_f32_bf16 v8, s35, v80
  v_dot2c_f32_bf16 v9, v80, v80
  v_dot2c_f32_bf16 v10, s35, v81
  v_dot2c_f32_bf16 v11, v81, v81
  v_dot2c_f32_bf16 v8, s35, v82
  v_dot2c_f32_bf16 v9, v82, v82
  v_dot2c_f32_bf16 v10, s35, v83
  v_dot2c_f32_bf16 v11, v83, v83
  v_dot2c_f32_bf16 v8, s35, v84
  v_dot2c_f32_bf16 v9, v84, v84
  v_dot2c_f32_bf16 v10, s35, v85
  v_dot2c_f32_bf16 v11, v85, v85
  v_dot2c_f32_bf16 v8, s35, v86
  v_dot2c_f32_bf16 v9, v86, v86
  v_dot2c_f32_bf16 v10, s35, v87
  v_dot2c_f32_bf16 v11, v87, v87
  s_waitcnt vmcnt(0)
  v_dot2c_f32_bf16 v8, s35, v88
  v_dot2c_f32_bf16 v9, v88, v88
  v_dot2c_f32_bf16 v10, s35, v89
  v_dot2c_f32_bf16 v11, v89, v89
  v_dot2c_f32_bf16 v8, s35, v90
  v_dot2c_f32_bf16 v9, v90, v90
  v_dot2c_f32_bf16 v10, s35, v91
  v_dot2c_f32_bf16 v11, v91, v91
  v_dot2c_f32_bf16 v8, s35, v92
  v_dot2c_f32_bf16 v9, v92, v92
  v_dot2c_f32_bf16 v10, s35, v93
  v_dot2c_f32_bf16 v11, v93, v93
  v_dot2c_f32_bf16 v8, s35, v94
  v_dot2c_f32_bf16 v9, v94, v94
  v_dot2c_f32_bf16 v10, s35, v95
  v_dot2c_f32_bf16 v11, v95, v95
  s_nop 2
  v_add_f32 v8, v8, v10
  v_add_f32 v9, v9, v11
  s_nop 0
  s_nop 0
  v_add_f32_dpp v8, v8, v8 quad_perm:[1,0,3,2] row_mask:0xf bank_mask:0xf
  v_add_f32_dpp v9, v9, v9 quad_perm:[1,0,3,2] row_mask:0xf bank_mask:0xf
  s_nop 0
  v_add_f32_dpp v8, v8, v8 quad_perm:[2,3,0,1] row_mask:0xf bank_mask:0xf
  v_add_f32_dpp v9, v9, v9 quad_perm:[2,3,0,1] row_mask:0xf bank_mask:0xf
  s_nop 0
  v_add_f32_dpp v8, v8, v8 row_half_mirror row_mask:0xf bank_mask:0xf
  v_add_f32_dpp v9, v9, v9 row_half_mirror row_mask:0xf bank_mask:0xf
  v_mul_f32 v8, 0x3b000000, v8
  v_mul_f32 v9, 0x3b000000, v9
  v_fma_f32 v9, -v8, v8, v9
  v_max_f32 v9, 0, v9
  v_add_f32 v9, 0x3727c5ac, v9
  v_rsq_f32 v10, v9
  s_nop 0
  v_mul_f32 v8, v8, v10
  v_sub_f32 v8, 0, v8
  v_mov_b32 v11, v10
  v_mov_b32 v9, v8
  v_lshlrev_b32 v16, 16, v64
  v_and_b32 v17, 0xffff0000, v64
  v_lshlrev_b32 v18, 16, v65
  v_and_b32 v19, 0xffff0000, v65
  v_lshlrev_b32 v20, 16, v66
  v_and_b32 v21, 0xffff0000, v66
  v_lshlrev_b32 v22, 16, v67
  v_and_b32 v23, 0xffff0000, v67
  v_pk_fma_f32 v[16:17], v[16:17], v[10:11], v[8:9]
  v_pk_fma_f32 v[18:19], v[18:19], v[10:11], v[8:9]
  v_pk_fma_f32 v[20:21], v[20:21], v[10:11], v[8:9]
  v_pk_fma_f32 v[22:23], v[22:23], v[10:11], v[8:9]
  v_cvt_pk_bf16_f32 v64, v16, v17
  v_cvt_pk_bf16_f32 v65, v18, v19
  v_cvt_pk_bf16_f32 v66, v20, v21
  v_cvt_pk_bf16_f32 v67, v22, v23
  ds_write_b128 v12, v[64:67] offset:0
  v_lshlrev_b32 v16, 16, v68
  v_and_b32 v17, 0xffff0000, v68
  v_lshlrev_b32 v18, 16, v69
  v_and_b32 v19, 0xffff0000, v69
  v_lshlrev_b32 v20, 16, v70
  v_and_b32 v21, 0xffff0000, v70
  v_lshlrev_b32 v22, 16, v71
  v_and_b32 v23, 0xffff0000, v71
  v_pk_fma_f32 v[16:17], v[16:17], v[10:11], v[8:9]
  v_pk_fma_f32 v[18:19], v[18:19], v[10:11], v[8:9]
  v_pk_fma_f32 v[20:21], v[20:21], v[10:11], v[8:9]
  v_pk_fma_f32 v[22:23], v[22:23], v[10:11], v[8:9]
  v_cvt_pk_bf16_f32 v68, v16, v17
  v_cvt_pk_bf16_f32 v69, v18, v19
  v_cvt_pk_bf16_f32 v70, v20, v21
  v_cvt_pk_bf16_f32 v71, v22, v23
  ds_write_b128 v12, v[68:71] offset:4224
  v_lshlrev_b32 v16, 16, v72
  v_and_b32 v17, 0xffff0000, v72
  v_lshlrev_b32 v18, 16, v73
  v_and_b32 v19, 0xffff0000, v73
  v_lshlrev_b32 v20, 16, v74
  v_and_b32 v21, 0xffff0000, v74
  v_lshlrev_b32 v22, 16, v75
  v_and_b32 v23, 0xffff0000, v75
  v_pk_fma_f32 v[16:17], v[16:17], v[10:11], v[8:9]
  v_pk_fma_f32 v[18:19], v[18:19], v[10:11], v[8:9]
  v_pk_fma_f32 v[20:21], v[20:21], v[10:11], v[8:9]
  v_pk_fma_f32 v[22:23], v[22:23], v[10:11], v[8:9]
  v_cvt_pk_bf16_f32 v72, v16, v17
  v_cvt_pk_bf16_f32 v73, v18, v19
  v_cvt_pk_bf16_f32 v74, v20, v21
  v_cvt_pk_bf16_f32 v75, v22, v23
  ds_write_b128 v12, v[72:75] offset:8448
  v_lshlrev_b32 v16, 16, v76
  v_and_b32 v17, 0xffff0000, v76
  v_lshlrev_b32 v18, 16, v77
  v_and_b32 v19, 0xffff0000, v77
  v_lshlrev_b32 v20, 16, v78
  v_and_b32 v21, 0xffff0000, v78
  v_lshlrev_b32 v22, 16, v79
  v_and_b32 v23, 0xffff0000, v79
  v_pk_fma_f32 v[16:17], v[16:17], v[10:11], v[8:9]
  v_pk_fma_f32 v[18:19], v[18:19], v[10:11], v[8:9]
  v_pk_fma_f32 v[20:21], v[20:21], v[10:11], v[8:9]
  v_pk_fma_f32 v[22:23], v[22:23], v[10:11], v[8:9]
  v_cvt_pk_bf16_f32 v76, v16, v17
  v_cvt_pk_bf16_f32 v77, v18, v19
  v_cvt_pk_bf16_f32 v78, v20, v21
  v_cvt_pk_bf16_f32 v79, v22, v23
  ds_write_b128 v12, v[76:79] offset:12672
  v_lshlrev_b32 v16, 16, v80
  v_and_b32 v17, 0xffff0000, v80
  v_lshlrev_b32 v18, 16, v81
  v_and_b32 v19, 0xffff0000, v81
  v_lshlrev_b32 v20, 16, v82
  v_and_b32 v21, 0xffff0000, v82
  v_lshlrev_b32 v22, 16, v83
  v_and_b32 v23, 0xffff0000, v83
  v_pk_fma_f32 v[16:17], v[16:17], v[10:11], v[8:9]
  v_pk_fma_f32 v[18:19], v[18:19], v[10:11], v[8:9]
  v_pk_fma_f32 v[20:21], v[20:21], v[10:11], v[8:9]
  v_pk_fma_f32 v[22:23], v[22:23], v[10:11], v[8:9]
  v_cvt_pk_bf16_f32 v80, v16, v17
  v_cvt_pk_bf16_f32 v81, v18, v19
  v_cvt_pk_bf16_f32 v82, v20, v21
  v_cvt_pk_bf16_f32 v83, v22, v23
  ds_write_b128 v12, v[80:83] offset:16896
  v_lshlrev_b32 v16, 16, v84
  v_and_b32 v17, 0xffff0000, v84
  v_lshlrev_b32 v18, 16, v85
  v_and_b32 v19, 0xffff0000, v85
  v_lshlrev_b32 v20, 16, v86
  v_and_b32 v21, 0xffff0000, v86
  v_lshlrev_b32 v22, 16, v87
  v_and_b32 v23, 0xffff0000, v87
  v_pk_fma_f32 v[16:17], v[16:17], v[10:11], v[8:9]
  v_pk_fma_f32 v[18:19], v[18:19], v[10:11], v[8:9]
  v_pk_fma_f32 v[20:21], v[20:21], v[10:11], v[8:9]
  v_pk_fma_f32 v[22:23], v[22:23], v[10:11], v[8:9]
  v_cvt_pk_bf16_f32 v84, v16, v17
  v_cvt_pk_bf16_f32 v85, v18, v19
  v_cvt_pk_bf16_f32 v86, v20, v21
  v_cvt_pk_bf16_f32 v87, v22, v23
  ds_write_b128 v12, v[84:87] offset:21120
  v_lshlrev_b32 v16, 16, v88
  v_and_b32 v17, 0xffff0000, v88
  v_lshlrev_b32 v18, 16, v89
  v_and_b32 v19, 0xffff0000, v89
  v_lshlrev_b32 v20, 16, v90
  v_and_b32 v21, 0xffff0000, v90
  v_lshlrev_b32 v22, 16, v91
  v_and_b32 v23, 0xffff0000, v91
  v_pk_fma_f32 v[16:17], v[16:17], v[10:11], v[8:9]
  v_pk_fma_f32 v[18:19], v[18:19], v[10:11], v[8:9]
  v_pk_fma_f32 v[20:21], v[20:21], v[10:11], v[8:9]
  v_pk_fma_f32 v[22:23], v[22:23], v[10:11], v[8:9]
  v_cvt_pk_bf16_f32 v88, v16, v17
  v_cvt_pk_bf16_f32 v89, v18, v19
  v_cvt_pk_bf16_f32 v90, v20, v21
  v_cvt_pk_bf16_f32 v91, v22, v23
  ds_write_b128 v12, v[88:91] offset:25344
  v_lshlrev_b32 v16, 16, v92
  v_and_b32 v17, 0xffff0000, v92
  v_lshlrev_b32 v18, 16, v93
  v_and_b32 v19, 0xffff0000, v93
  v_lshlrev_b32 v20, 16, v94
  v_and_b32 v21, 0xffff0000, v94
  v_lshlrev_b32 v22, 16, v95
  v_and_b32 v23, 0xffff0000, v95
  v_pk_fma_f32 v[16:17], v[16:17], v[10:11], v[8:9]
  v_pk_fma_f32 v[18:19], v[18:19], v[10:11], v[8:9]
  v_pk_fma_f32 v[20:21], v[20:21], v[10:11], v[8:9]
  v_pk_fma_f32 v[22:23], v[22:23], v[10:11], v[8:9]
  v_cvt_pk_bf16_f32 v92, v16, v17
  v_cvt_pk_bf16_f32 v93, v18, v19
  v_cvt_pk_bf16_f32 v94, v20, v21
  v_cvt_pk_bf16_f32 v95, v22, v23
  ds_write_b128 v12, v[92:95] offset:29568
  s_add_u32 m0, s37, 67584
  s_add_u32 s36, s34, 1024
  buffer_load_dwordx4 v4, s[12:15], s36 offen lds
  buffer_load_dwordx4 v13, s[12:15], s36 offen offset:1024 lds
  s_add_u32 m0, s37, 75776
  s_add_u32 s36, s34, 2048
  buffer_load_dwordx4 v4, s[12:15], s36 offen lds
  buffer_load_dwordx4 v13, s[12:15], s36 offen offset:1024 lds
  s_add_u32 m0, s37, 83968
  s_add_u32 s36, s34, 197632
  buffer_load_dwordx4 v4, s[12:15], s36 offen lds
  buffer_load_dwordx4 v13, s[12:15], s36 offen offset:1024 lds
  s_add_u32 m0, s37, 92160
  s_add_u32 s36, s34, 198656
  buffer_load_dwordx4 v4, s[12:15], s36 offen lds
  buffer_load_dwordx4 v13, s[12:15], s36 offen offset:1024 lds
  s_add_u32 m0, s37, 100352
  s_add_u32 s36, s34, 394240
  buffer_load_dwordx4 v4, s[12:15], s36 offen lds
  buffer_load_dwordx4 v13, s[12:15], s36 offen offset:1024 lds
  s_add_u32 m0, s37, 108544
  s_add_u32 s36, s34, 395264
  buffer_load_dwordx4 v4, s[12:15], s36 offen lds
  buffer_load_dwordx4 v13, s[12:15], s36 offen offset:1024 lds
  s_add_u32 s16, s84, 2097152
  s_addc_u32 s17, s85, 0
  s_and_b32 s17, s17, 0xffff
  s_mov_b32 s18, 6291456
  s_mov_b32 s19, 0x20000
  s_add_u32 s20, s84, 21102592
  s_addc_u32 s21, s85, 0
  s_and_b32 s21, s21, 0xffff
  s_mov_b32 s22, 16384
  s_mov_b32 s23, 0x20000
  s_mov_b32 s48, s82
  s_and_b32 s49, s83, 0xffff
  s_mov_b32 s50, 256
  s_mov_b32 s51, 0x20000
  v_mov_b32 v250, 0
  s_and_b32 s30, s24, 1
  s_lshr_b32 s31, s24, 1
  v_lshrrev_b32 v14, 5, v1
  v_mul_u32_u24 v15, 528, v14
  v_and_b32 v12, 31, v1
  v_lshl_add_u32 v4, v12, 4, v15
  s_mul_i32 s34, s30, 33792
  v_add_u32 v4, s34, v4
  buffer_load_dword v249, v250, s[48:51], 0 offen sc1
  v_bfe_u32 v16, v1, 2, 2
  v_lshrrev_b32 v17, 5, v1
  v_lshl_add_u32 v17, v17, 3, v16
  v_lshlrev_b32 v5, 7, v17
  v_bfe_u32 v17, v1, 4, 1
  v_and_b32 v18, 1, v1
  v_lshl_add_u32 v17, v17, 1, v18
  s_lshl_b32 s59, s31, 2
  v_add_u32 v17, s59, v17
  v_lshrrev_b32 v16, 1, v16
  v_lshlrev_b32 v16, 2, v16
  v_xor_b32 v17, v17, v16
  v_lshl_add_u32 v5, v17, 4, v5
  v_bfe_u32 v18, v1, 1, 1
  v_lshl_add_u32 v5, v18, 3, v5
  v_add_u32 v6, 0x10000, v5
  v_add_u32 v7, 0x20000, v5
  v_mov_b32 v16, 0
  v_mov_b32 v17, 0
  v_mov_b32 v18, 0
  v_mov_b32 v19, 0
  v_mov_b32 v20, 0
  v_mov_b32 v21, 0
  v_mov_b32 v22, 0
  v_mov_b32 v23, 0
  v_mov_b32 v24, 0
  v_mov_b32 v25, 0
  v_mov_b32 v26, 0
  v_mov_b32 v27, 0
  v_mov_b32 v28, 0
  v_mov_b32 v29, 0
  v_mov_b32 v30, 0
  v_mov_b32 v31, 0
  v_mov_b32 v32, 0
  v_mov_b32 v33, 0
  v_mov_b32 v34, 0
  v_mov_b32 v35, 0
  v_mov_b32 v36, 0
  v_mov_b32 v37, 0
  v_mov_b32 v38, 0
  v_mov_b32 v39, 0
  v_mov_b32 v40, 0
  v_mov_b32 v41, 0
  v_mov_b32 v42, 0
  v_mov_b32 v43, 0
  v_mov_b32 v44, 0
  v_mov_b32 v45, 0
  v_mov_b32 v46, 0
  v_mov_b32 v47, 0
  v_mov_b32 v48, 0
  v_mov_b32 v49, 0
  v_mov_b32 v50, 0
  v_mov_b32 v51, 0
  v_mov_b32 v52, 0
  v_mov_b32 v53, 0
  v_mov_b32 v54, 0
  v_mov_b32 v55, 0
  v_mov_b32 v56, 0
  v_mov_b32 v57, 0
  v_mov_b32 v58, 0
  v_mov_b32 v59, 0
  v_mov_b32 v60, 0
  v_mov_b32 v61, 0
  v_mov_b32 v62, 0
  v_mov_b32 v63, 0
  v_and_b32 v14, 4, v12
  v_and_b32 v15, 8, v12
  v_lshlrev_b32 v14, 1, v14
  v_lshrrev_b32 v15, 1, v15
  v_and_b32 v13, 0xfffffff3, v12
  v_or3_b32 v13, v13, v14, v15
  v_lshrrev_b32 v14, 5, v1
  v_lshlrev_b32 v8, 9, v14
  v_lshl_add_u32 v8, v13, 4, v8
  s_lshl_b32 s38, s25, 1
  s_add_u32 s38, s38, s30
  s_lshl_b32 s39, s26, 2
  s_lshl_b32 s40, s31, 1
  s_add_u32 s39, s39, s40
  s_lshl_b32 s40, s39, 16
  s_lshl_b32 s41, s38, 10
  s_add_u32 s40, s40, s41
  s_mov_b32 s42, 0x3eb8aa3b
  v_bfe_u32 v9, v1, 4, 1
  v_lshlrev_b32 v9, 16, v9
  v_and_b32 v10, 15, v1
  v_lshl_add_u32 v9, v10, 4, v9
  v_lshl_add_u32 v9, v14, 8, v9
  s_waitcnt lgkmcnt(0)
  s_barrier
  s_waitcnt vmcnt(9)
  s_barrier
  ds_read_b128 v[64:67], v4 offset:0
  ds_read_b64_tr_b16 v[68:69], v6 offset:2048
  ds_read_b64_tr_b16 v[70:71], v6 offset:2560
  ds_read_b64_tr_b16 v[72:73], v6 offset:10240
  ds_read_b64_tr_b16 v[74:75], v6 offset:10752
  ds_read_b128 v[76:79], v4 offset:1056
  ds_read_b64_tr_b16 v[80:81], v6 offset:4096
  ds_read_b64_tr_b16 v[82:83], v6 offset:4608
  ds_read_b64_tr_b16 v[84:85], v6 offset:12288
  ds_read_b64_tr_b16 v[86:87], v6 offset:12800
  ds_read_b128 v[88:91], v4 offset:2112
  ds_read_b64_tr_b16 v[92:93], v6 offset:6144
  ds_read_b64_tr_b16 v[94:95], v6 offset:6656
  ds_read_b64_tr_b16 v[96:97], v6 offset:14336
  ds_read_b64_tr_b16 v[98:99], v6 offset:14848
  ds_read_b128 v[100:103], v4 offset:3168
  ds_read_b64_tr_b16 v[104:105], v6 offset:8192
  ds_read_b64_tr_b16 v[106:107], v6 offset:8704
  ds_read_b64_tr_b16 v[108:109], v6 offset:16384
  ds_read_b64_tr_b16 v[110:111], v6 offset:16896
  s_waitcnt vmcnt(5)
  s_barrier
  s_waitcnt lgkmcnt(0)
  v_mfma_f32_32x32x16_bf16 v[32:47], v[68:71], v[64:67], v[32:47]
  ds_read_b128 v[128:131], v4 offset:4224
  ds_read_b64_tr_b16 v[132:133], v6 offset:18432
  ds_read_b64_tr_b16 v[134:135], v6 offset:18944
  v_mfma_f32_32x32x16_bf16 v[48:63], v[64:67], v[72:75], v[48:63]
  ds_read_b64_tr_b16 v[136:137], v6 offset:26624
  ds_read_b64_tr_b16 v[138:139], v6 offset:27136
  ds_read_b128 v[140:143], v4 offset:5280
  v_mfma_f32_32x32x16_bf16 v[32:47], v[80:83], v[76:79], v[32:47]
  ds_read_b64_tr_b16 v[144:145], v6 offset:20480
  ds_read_b64_tr_b16 v[146:147], v6 offset:20992
  ds_read_b64_tr_b16 v[148:149], v6 offset:28672
  v_mfma_f32_32x32x16_bf16 v[48:63], v[76:79], v[84:87], v[48:63]
  ds_read_b64_tr_b16 v[150:151], v6 offset:29184
  ds_read_b128 v[152:155], v4 offset:6336
  ds_read_b64_tr_b16 v[156:157], v6 offset:22528
  v_mfma_f32_32x32x16_bf16 v[32:47], v[92:95], v[88:91], v[32:47]
  ds_read_b64_tr_b16 v[158:159], v6 offset:23040
  ds_read_b64_tr_b16 v[160:161], v6 offset:30720
  ds_read_b64_tr_b16 v[162:163], v6 offset:31232
  v_mfma_f32_32x32x16_bf16 v[48:63], v[88:91], v[96:99], v[48:63]
  ds_read_b128 v[164:167], v4 offset:7392
  ds_read_b64_tr_b16 v[168:169], v6 offset:24576
  ds_read_b64_tr_b16 v[170:171], v6 offset:25088
  v_mfma_f32_32x32x16_bf16 v[32:47], v[104:107], v[100:103], v[32:47]
  ds_read_b64_tr_b16 v[172:173], v6 offset:32768
  ds_read_b64_tr_b16 v[174:175], v6 offset:33280
  v_mfma_f32_32x32x16_bf16 v[48:63], v[100:103], v[108:111], v[48:63]
  s_waitcnt vmcnt(1)
  s_barrier
  s_waitcnt lgkmcnt(0)
  v_mfma_f32_32x32x16_bf16 v[32:47], v[132:135], v[128:131], v[32:47]
  ds_read_b128 v[64:67], v4 offset:8448
  ds_read_b64_tr_b16 v[68:69], v6 offset:34816
  ds_read_b64_tr_b16 v[70:71], v6 offset:35328
  v_mfma_f32_32x32x16_bf16 v[48:63], v[128:131], v[136:139], v[48:63]
  ds_read_b64_tr_b16 v[72:73], v6 offset:43008
  ds_read_b64_tr_b16 v[74:75], v6 offset:43520
  ds_read_b128 v[76:79], v4 offset:9504
  v_mfma_f32_32x32x16_bf16 v[32:47], v[144:147], v[140:143], v[32:47]
  ds_read_b64_tr_b16 v[80:81], v6 offset:36864
  ds_read_b64_tr_b16 v[82:83], v6 offset:37376
  ds_read_b64_tr_b16 v[84:85], v6 offset:45056
  v_mfma_f32_32x32x16_bf16 v[48:63], v[140:143], v[148:151], v[48:63]
  ds_read_b64_tr_b16 v[86:87], v6 offset:45568
  ds_read_b128 v[88:91], v4 offset:10560
  ds_read_b64_tr_b16 v[92:93], v6 offset:38912
  v_mfma_f32_32x32x16_bf16 v[32:47], v[156:159], v[152:155], v[32:47]
  ds_read_b64_tr_b16 v[94:95], v6 offset:39424
  ds_read_b64_tr_b16 v[96:97], v6 offset:47104
  ds_read_b64_tr_b16 v[98:99], v6 offset:47616
  v_mfma_f32_32x32x16_bf16 v[48:63], v[152:155], v[160:163], v[48:63]
  ds_read_b128 v[100:103], v4 offset:11616
  ds_read_b64_tr_b16 v[104:105], v6 offset:40960
  ds_read_b64_tr_b16 v[106:107], v6 offset:41472
  v_mfma_f32_32x32x16_bf16 v[32:47], v[168:171], v[164:167], v[32:47]
  ds_read_b64_tr_b16 v[108:109], v6 offset:49152
  ds_read_b64_tr_b16 v[110:111], v6 offset:49664
  v_mfma_f32_32x32x16_bf16 v[48:63], v[164:167], v[172:175], v[48:63]
  s_barrier
  s_waitcnt lgkmcnt(0)
  v_mfma_f32_32x32x16_bf16 v[32:47], v[68:71], v[64:67], v[32:47]
  ds_read_b128 v[128:131], v4 offset:12672
  ds_read_b64_tr_b16 v[132:133], v6 offset:51200
  ds_read_b64_tr_b16 v[134:135], v6 offset:51712
  v_mfma_f32_32x32x16_bf16 v[48:63], v[64:67], v[72:75], v[48:63]
  ds_read_b64_tr_b16 v[136:137], v6 offset:59392
  ds_read_b64_tr_b16 v[138:139], v6 offset:59904
  ds_read_b128 v[140:143], v4 offset:13728
  v_mfma_f32_32x32x16_bf16 v[32:47], v[80:83], v[76:79], v[32:47]
  ds_read_b64_tr_b16 v[144:145], v6 offset:53248
  ds_read_b64_tr_b16 v[146:147], v6 offset:53760
  ds_read_b64_tr_b16 v[148:149], v6 offset:61440
  v_mfma_f32_32x32x16_bf16 v[48:63], v[76:79], v[84:87], v[48:63]
  ds_read_b64_tr_b16 v[150:151], v6 offset:61952
  ds_read_b128 v[152:155], v4 offset:14784
  ds_read_b64_tr_b16 v[156:157], v6 offset:55296
  v_mfma_f32_32x32x16_bf16 v[32:47], v[92:95], v[88:91], v[32:47]
  ds_read_b64_tr_b16 v[158:159], v6 offset:55808
  ds_read_b64_tr_b16 v[160:161], v6 offset:63488
  ds_read_b64_tr_b16 v[162:163], v6 offset:64000
  v_mfma_f32_32x32x16_bf16 v[48:63], v[88:91], v[96:99], v[48:63]
  ds_read_b128 v[164:167], v4 offset:15840
  ds_read_b64_tr_b16 v[168:169], v6 offset:57344
  ds_read_b64_tr_b16 v[170:171], v6 offset:57856
  v_mfma_f32_32x32x16_bf16 v[32:47], v[104:107], v[100:103], v[32:47]
  ds_read_b64_tr_b16 v[172:173], v7 offset:0
  ds_read_b64_tr_b16 v[174:175], v7 offset:512
  v_mfma_f32_32x32x16_bf16 v[48:63], v[100:103], v[108:111], v[48:63]
  s_barrier
  s_waitcnt lgkmcnt(0)
  v_mfma_f32_32x32x16_bf16 v[32:47], v[132:135], v[128:131], v[32:47]
  ds_read_b128 v[64:67], v4 offset:16896
  ds_read_b64_tr_b16 v[68:69], v7 offset:2048
  ds_read_b64_tr_b16 v[70:71], v7 offset:2560
  v_mfma_f32_32x32x16_bf16 v[48:63], v[128:131], v[136:139], v[48:63]
  ds_read_b64_tr_b16 v[72:73], v7 offset:10240
  ds_read_b64_tr_b16 v[74:75], v7 offset:10752
  ds_read_b128 v[76:79], v4 offset:17952
  v_mfma_f32_32x32x16_bf16 v[32:47], v[144:147], v[140:143], v[32:47]
  ds_read_b64_tr_b16 v[80:81], v7 offset:4096
  ds_read_b64_tr_b16 v[82:83], v7 offset:4608
  ds_read_b64_tr_b16 v[84:85], v7 offset:12288
  v_mfma_f32_32x32x16_bf16 v[48:63], v[140:143], v[148:151], v[48:63]
  ds_read_b64_tr_b16 v[86:87], v7 offset:12800
  ds_read_b128 v[88:91], v4 offset:19008
  ds_read_b64_tr_b16 v[92:93], v7 offset:6144
  v_mfma_f32_32x32x16_bf16 v[32:47], v[156:159], v[152:155], v[32:47]
  ds_read_b64_tr_b16 v[94:95], v7 offset:6656
  ds_read_b64_tr_b16 v[96:97], v7 offset:14336
  ds_read_b64_tr_b16 v[98:99], v7 offset:14848
  v_mfma_f32_32x32x16_bf16 v[48:63], v[152:155], v[160:163], v[48:63]
  ds_read_b128 v[100:103], v4 offset:20064
  ds_read_b64_tr_b16 v[104:105], v7 offset:8192
  ds_read_b64_tr_b16 v[106:107], v7 offset:8704
  v_mfma_f32_32x32x16_bf16 v[32:47], v[168:171], v[164:167], v[32:47]
  ds_read_b64_tr_b16 v[108:109], v7 offset:16384
  ds_read_b64_tr_b16 v[110:111], v7 offset:16896
  v_mfma_f32_32x32x16_bf16 v[48:63], v[164:167], v[172:175], v[48:63]
  s_barrier
  s_waitcnt lgkmcnt(0)
  v_mfma_f32_32x32x16_bf16 v[32:47], v[68:71], v[64:67], v[32:47]
  ds_read_b128 v[128:131], v4 offset:21120
  ds_read_b64_tr_b16 v[132:133], v6 offset:2048
  ds_read_b64_tr_b16 v[134:135], v6 offset:2560
  v_mfma_f32_32x32x16_bf16 v[48:63], v[64:67], v[72:75], v[48:63]
  ds_read_b64_tr_b16 v[136:137], v6 offset:10240
  ds_read_b64_tr_b16 v[138:139], v6 offset:10752
  ds_read_b128 v[140:143], v4 offset:22176
  v_mfma_f32_32x32x16_bf16 v[32:47], v[80:83], v[76:79], v[32:47]
  ds_read_b64_tr_b16 v[144:145], v6 offset:4096
  ds_read_b64_tr_b16 v[146:147], v6 offset:4608
  ds_read_b64_tr_b16 v[148:149], v6 offset:12288
  v_mfma_f32_32x32x16_bf16 v[48:63], v[76:79], v[84:87], v[48:63]
  ds_read_b64_tr_b16 v[150:151], v6 offset:12800
  ds_read_b128 v[152:155], v4 offset:23232
  ds_read_b64_tr_b16 v[156:157], v6 offset:6144
  v_mfma_f32_32x32x16_bf16 v[32:47], v[92:95], v[88:91], v[32:47]
  ds_read_b64_tr_b16 v[158:159], v6 offset:6656
  ds_read_b64_tr_b16 v[160:161], v6 offset:14336
  ds_read_b64_tr_b16 v[162:163], v6 offset:14848
  v_mfma_f32_32x32x16_bf16 v[48:63], v[88:91], v[96:99], v[48:63]
  ds_read_b128 v[164:167], v4 offset:24288
  ds_read_b64_tr_b16 v[168:169], v6 offset:8192
  ds_read_b64_tr_b16 v[170:171], v6 offset:8704
  v_mfma_f32_32x32x16_bf16 v[32:47], v[104:107], v[100:103], v[32:47]
  ds_read_b64_tr_b16 v[172:173], v6 offset:16384
  ds_read_b64_tr_b16 v[174:175], v6 offset:16896
  v_mfma_f32_32x32x16_bf16 v[48:63], v[100:103], v[108:111], v[48:63]
  s_barrier
  s_waitcnt lgkmcnt(0)
  v_mfma_f32_32x32x16_bf16 v[32:47], v[132:135], v[128:131], v[32:47]
  ds_read_b128 v[64:67], v4 offset:25344
  ds_read_b64_tr_b16 v[68:69], v6 offset:18432
  ds_read_b64_tr_b16 v[70:71], v6 offset:18944
  v_mfma_f32_32x32x16_bf16 v[48:63], v[128:131], v[136:139], v[48:63]
  ds_read_b64_tr_b16 v[72:73], v6 offset:26624
  ds_read_b64_tr_b16 v[74:75], v6 offset:27136
  ds_read_b128 v[76:79], v4 offset:26400
  v_mfma_f32_32x32x16_bf16 v[32:47], v[144:147], v[140:143], v[32:47]
  ds_read_b64_tr_b16 v[80:81], v6 offset:20480
  ds_read_b64_tr_b16 v[82:83], v6 offset:20992
  ds_read_b64_tr_b16 v[84:85], v6 offset:28672
  v_mfma_f32_32x32x16_bf16 v[48:63], v[140:143], v[148:151], v[48:63]
  ds_read_b64_tr_b16 v[86:87], v6 offset:29184
  ds_read_b128 v[88:91], v4 offset:27456
  ds_read_b64_tr_b16 v[92:93], v6 offset:22528
  v_mfma_f32_32x32x16_bf16 v[32:47], v[156:159], v[152:155], v[32:47]
  ds_read_b64_tr_b16 v[94:95], v6 offset:23040
  ds_read_b64_tr_b16 v[96:97], v6 offset:30720
  ds_read_b64_tr_b16 v[98:99], v6 offset:31232
  v_mfma_f32_32x32x16_bf16 v[48:63], v[152:155], v[160:163], v[48:63]
  ds_read_b128 v[100:103], v4 offset:28512
  ds_read_b64_tr_b16 v[104:105], v6 offset:24576
  ds_read_b64_tr_b16 v[106:107], v6 offset:25088
  v_mfma_f32_32x32x16_bf16 v[32:47], v[168:171], v[164:167], v[32:47]
  ds_read_b64_tr_b16 v[108:109], v6 offset:32768
  ds_read_b64_tr_b16 v[110:111], v6 offset:33280
  v_mfma_f32_32x32x16_bf16 v[48:63], v[164:167], v[172:175], v[48:63]
  s_barrier
  s_waitcnt lgkmcnt(0)
  v_mfma_f32_32x32x16_bf16 v[32:47], v[68:71], v[64:67], v[32:47]
  ds_read_b128 v[128:131], v4 offset:29568
  ds_read_b64_tr_b16 v[132:133], v6 offset:34816
  ds_read_b64_tr_b16 v[134:135], v6 offset:35328
  v_mfma_f32_32x32x16_bf16 v[48:63], v[64:67], v[72:75], v[48:63]
  ds_read_b64_tr_b16 v[136:137], v6 offset:43008
  ds_read_b64_tr_b16 v[138:139], v6 offset:43520
  ds_read_b128 v[140:143], v4 offset:30624
  v_mfma_f32_32x32x16_bf16 v[32:47], v[80:83], v[76:79], v[32:47]
  ds_read_b64_tr_b16 v[144:145], v6 offset:36864
  ds_read_b64_tr_b16 v[146:147], v6 offset:37376
  ds_read_b64_tr_b16 v[148:149], v6 offset:45056
  v_mfma_f32_32x32x16_bf16 v[48:63], v[76:79], v[84:87], v[48:63]
  ds_read_b64_tr_b16 v[150:151], v6 offset:45568
  ds_read_b128 v[152:155], v4 offset:31680
  ds_read_b64_tr_b16 v[156:157], v6 offset:38912
  v_mfma_f32_32x32x16_bf16 v[32:47], v[92:95], v[88:91], v[32:47]
  ds_read_b64_tr_b16 v[158:159], v6 offset:39424
  ds_read_b64_tr_b16 v[160:161], v6 offset:47104
  ds_read_b64_tr_b16 v[162:163], v6 offset:47616
  v_mfma_f32_32x32x16_bf16 v[48:63], v[88:91], v[96:99], v[48:63]
  ds_read_b128 v[164:167], v4 offset:32736
  ds_read_b64_tr_b16 v[168:169], v6 offset:40960
  ds_read_b64_tr_b16 v[170:171], v6 offset:41472
  v_mfma_f32_32x32x16_bf16 v[32:47], v[104:107], v[100:103], v[32:47]
  ds_read_b64_tr_b16 v[172:173], v6 offset:49152
  ds_read_b64_tr_b16 v[174:175], v6 offset:49664
  v_mfma_f32_32x32x16_bf16 v[48:63], v[100:103], v[108:111], v[48:63]
  s_barrier
  s_waitcnt lgkmcnt(0)
  v_mfma_f32_32x32x16_bf16 v[32:47], v[132:135], v[128:131], v[32:47]
  ds_read_b128 v[64:67], v4 offset:0
  ds_read_b64_tr_b16 v[68:69], v6 offset:51200
  ds_read_b64_tr_b16 v[70:71], v6 offset:51712
  v_mfma_f32_32x32x16_bf16 v[48:63], v[128:131], v[136:139], v[48:63]
  ds_read_b128 v[72:75], v4 offset:1056
  ds_read_b64_tr_b16 v[76:77], v6 offset:53248
  ds_read_b64_tr_b16 v[78:79], v6 offset:53760
  v_mfma_f32_32x32x16_bf16 v[32:47], v[144:147], v[140:143], v[32:47]
  ds_read_b128 v[80:83], v4 offset:2112
  ds_read_b64_tr_b16 v[84:85], v6 offset:55296
  ds_read_b64_tr_b16 v[86:87], v6 offset:55808
  v_mfma_f32_32x32x16_bf16 v[48:63], v[140:143], v[148:151], v[48:63]
  ds_read_b128 v[88:91], v4 offset:3168
  ds_read_b64_tr_b16 v[92:93], v6 offset:57344
  ds_read_b64_tr_b16 v[94:95], v6 offset:57856
  v_mfma_f32_32x32x16_bf16 v[32:47], v[156:159], v[152:155], v[32:47]
  ds_read_b128 v[96:99], v4 offset:4224
  ds_read_b64_tr_b16 v[100:101], v6 offset:59392
  ds_read_b64_tr_b16 v[102:103], v6 offset:59904
  v_mfma_f32_32x32x16_bf16 v[48:63], v[152:155], v[160:163], v[48:63]
  ds_read_b128 v[104:107], v4 offset:5280
  ds_read_b64_tr_b16 v[108:109], v6 offset:61440
  ds_read_b64_tr_b16 v[110:111], v6 offset:61952
  v_mfma_f32_32x32x16_bf16 v[32:47], v[168:171], v[164:167], v[32:47]
  ds_read_b128 v[112:115], v4 offset:6336
  ds_read_b64_tr_b16 v[116:117], v6 offset:63488
  ds_read_b64_tr_b16 v[118:119], v6 offset:64000
  v_mfma_f32_32x32x16_bf16 v[48:63], v[164:167], v[172:175], v[48:63]
  ds_read_b128 v[120:123], v4 offset:7392
  ds_read_b64_tr_b16 v[124:125], v7 offset:0
  ds_read_b64_tr_b16 v[126:127], v7 offset:512
  s_barrier
  s_waitcnt lgkmcnt(0)
  v_mfma_f32_32x32x16_bf16 v[16:31], v[68:71], v[64:67], v[16:31]
  ds_read_b128 v[128:131], v4 offset:8448
  ds_read_b64_tr_b16 v[132:133], v7 offset:2048
  ds_read_b64_tr_b16 v[134:135], v7 offset:2560
  s_nop 4
  v_cvt_pk_bf16_f32 v192, v32, v33
  v_cvt_pk_bf16_f32 v193, v34, v35
  v_mfma_f32_32x32x16_bf16 v[16:31], v[76:79], v[72:75], v[16:31]
  ds_read_b128 v[136:139], v4 offset:9504
  ds_read_b64_tr_b16 v[140:141], v7 offset:4096
  ds_read_b64_tr_b16 v[142:143], v7 offset:4608
  v_cvt_pk_bf16_f32 v194, v36, v37
  v_cvt_pk_bf16_f32 v195, v38, v39
  s_add_u32 s43, s40, 2097152
  v_mfma_f32_32x32x16_bf16 v[16:31], v[84:87], v[80:83], v[16:31]
  ds_read_b128 v[144:147], v4 offset:10560
  ds_read_b64_tr_b16 v[148:149], v7 offset:6144
  ds_read_b64_tr_b16 v[150:151], v7 offset:6656
  buffer_store_dwordx4 v[192:195], v8, s[16:19], s43 offen sc1
  v_cvt_pk_bf16_f32 v196, v40, v41
  v_cvt_pk_bf16_f32 v197, v42, v43
  v_mfma_f32_32x32x16_bf16 v[16:31], v[92:95], v[88:91], v[16:31]
  ds_read_b128 v[152:155], v4 offset:11616
  ds_read_b64_tr_b16 v[156:157], v7 offset:8192
  ds_read_b64_tr_b16 v[158:159], v7 offset:8704
  v_cvt_pk_bf16_f32 v198, v44, v45
  v_cvt_pk_bf16_f32 v199, v46, v47
  s_add_u32 s43, s40, 2162688
  v_mfma_f32_32x32x16_bf16 v[16:31], v[100:103], v[96:99], v[16:31]
  ds_read_b128 v[160:163], v4 offset:12672
  ds_read_b64_tr_b16 v[164:165], v7 offset:10240
  ds_read_b64_tr_b16 v[166:167], v7 offset:10752
  buffer_store_dwordx4 v[196:199], v8, s[16:19], s43 offen sc1
  v_cvt_pk_bf16_f32 v200, v48, v49
  v_cvt_pk_bf16_f32 v201, v50, v51
  v_mfma_f32_32x32x16_bf16 v[16:31], v[108:111], v[104:107], v[16:31]
  ds_read_b128 v[168:171], v4 offset:13728
  ds_read_b64_tr_b16 v[172:173], v7 offset:12288
  ds_read_b64_tr_b16 v[174:175], v7 offset:12800
  v_cvt_pk_bf16_f32 v202, v52, v53
  v_cvt_pk_bf16_f32 v203, v54, v55
  v_mfma_f32_32x32x16_bf16 v[16:31], v[116:119], v[112:115], v[16:31]
  ds_read_b128 v[176:179], v4 offset:14784
  ds_read_b64_tr_b16 v[180:181], v7 offset:14336
  ds_read_b64_tr_b16 v[182:183], v7 offset:14848
  v_mfma_f32_32x32x16_bf16 v[16:31], v[124:127], v[120:123], v[16:31]
  ds_read_b128 v[184:187], v4 offset:15840
  ds_read_b64_tr_b16 v[188:189], v7 offset:16384
  ds_read_b64_tr_b16 v[190:191], v7 offset:16896
  s_barrier
  s_waitcnt lgkmcnt(0)
  v_mfma_f32_32x32x16_bf16 v[16:31], v[132:135], v[128:131], v[16:31]
  ds_read_b128 v[64:67], v4 offset:16896
  ds_read_b64_tr_b16 v[68:69], v6 offset:2048
  ds_read_b64_tr_b16 v[70:71], v6 offset:2560
  s_add_u32 s43, s40, 4194304
  buffer_store_dwordx4 v[200:203], v9, s[16:19], s43 offen sc1
  v_mfma_f32_32x32x16_bf16 v[16:31], v[140:143], v[136:139], v[16:31]
  ds_read_b128 v[72:75], v4 offset:17952
  ds_read_b64_tr_b16 v[76:77], v6 offset:4096
  ds_read_b64_tr_b16 v[78:79], v6 offset:4608
  v_cvt_pk_bf16_f32 v204, v56, v57
  v_cvt_pk_bf16_f32 v205, v58, v59
  v_mfma_f32_32x32x16_bf16 v[16:31], v[148:151], v[144:147], v[16:31]
  ds_read_b128 v[80:83], v4 offset:19008
  ds_read_b64_tr_b16 v[84:85], v6 offset:6144
  ds_read_b64_tr_b16 v[86:87], v6 offset:6656
  v_cvt_pk_bf16_f32 v206, v60, v61
  v_cvt_pk_bf16_f32 v207, v62, v63
  v_mfma_f32_32x32x16_bf16 v[16:31], v[156:159], v[152:155], v[16:31]
  ds_read_b128 v[88:91], v4 offset:20064
  ds_read_b64_tr_b16 v[92:93], v6 offset:8192
  ds_read_b64_tr_b16 v[94:95], v6 offset:8704
  s_add_u32 s43, s40, 4194816
  buffer_store_dwordx4 v[204:207], v9, s[16:19], s43 offen sc1
  v_mfma_f32_32x32x16_bf16 v[16:31], v[164:167], v[160:163], v[16:31]
  ds_read_b128 v[96:99], v4 offset:21120
  ds_read_b64_tr_b16 v[100:101], v6 offset:10240
  ds_read_b64_tr_b16 v[102:103], v6 offset:10752
  v_mul_f32 v218, v32, v32
  v_mul_f32 v219, v40, v40
  v_mfma_f32_32x32x16_bf16 v[16:31], v[172:175], v[168:171], v[16:31]
  ds_read_b128 v[104:107], v4 offset:22176
  ds_read_b64_tr_b16 v[108:109], v6 offset:12288
  ds_read_b64_tr_b16 v[110:111], v6 offset:12800
  v_fmac_f32 v218, v33, v33
  v_fmac_f32 v219, v41, v41
  v_mfma_f32_32x32x16_bf16 v[16:31], v[180:183], v[176:179], v[16:31]
  ds_read_b128 v[112:115], v4 offset:23232
  ds_read_b64_tr_b16 v[116:117], v6 offset:14336
  ds_read_b64_tr_b16 v[118:119], v6 offset:14848
  v_fmac_f32 v218, v34, v34
  v_fmac_f32 v219, v42, v42
  v_mfma_f32_32x32x16_bf16 v[16:31], v[188:191], v[184:187], v[16:31]
  ds_read_b128 v[120:123], v4 offset:24288
  ds_read_b64_tr_b16 v[124:125], v6 offset:16384
  ds_read_b64_tr_b16 v[126:127], v6 offset:16896
  v_fmac_f32 v218, v35, v35
  v_fmac_f32 v219, v43, v43
  s_barrier
  s_waitcnt lgkmcnt(0)
  v_mfma_f32_32x32x16_bf16 v[16:31], v[68:71], v[64:67], v[16:31]
  ds_read_b128 v[128:131], v4 offset:25344
  ds_read_b64_tr_b16 v[132:133], v6 offset:18432
  ds_read_b64_tr_b16 v[134:135], v6 offset:18944
  v_fmac_f32 v218, v36, v36
  v_fmac_f32 v219, v44, v44
  v_mfma_f32_32x32x16_bf16 v[16:31], v[76:79], v[72:75], v[16:31]
  ds_read_b128 v[136:139], v4 offset:26400
  ds_read_b64_tr_b16 v[140:141], v6 offset:20480
  ds_read_b64_tr_b16 v[142:143], v6 offset:20992
  v_fmac_f32 v218, v37, v37
  v_fmac_f32 v219, v45, v45
  v_mfma_f32_32x32x16_bf16 v[16:31], v[84:87], v[80:83], v[16:31]
  ds_read_b128 v[144:147], v4 offset:27456
  ds_read_b64_tr_b16 v[148:149], v6 offset:22528
  ds_read_b64_tr_b16 v[150:151], v6 offset:23040
  v_fmac_f32 v218, v38, v38
  v_fmac_f32 v219, v46, v46
  v_mfma_f32_32x32x16_bf16 v[16:31], v[92:95], v[88:91], v[16:31]
  ds_read_b128 v[152:155], v4 offset:28512
  ds_read_b64_tr_b16 v[156:157], v6 offset:24576
  ds_read_b64_tr_b16 v[158:159], v6 offset:25088
  v_fmac_f32 v218, v39, v39
  v_fmac_f32 v219, v47, v47
  v_mfma_f32_32x32x16_bf16 v[16:31], v[100:103], v[96:99], v[16:31]
  ds_read_b128 v[160:163], v4 offset:29568
  ds_read_b64_tr_b16 v[164:165], v6 offset:26624
  ds_read_b64_tr_b16 v[166:167], v6 offset:27136
  v_max3_f32 v220, |v48|, |v49|, |v50|
  v_max3_f32 v220, |v51|, |v52|, v220
  v_mfma_f32_32x32x16_bf16 v[16:31], v[108:111], v[104:107], v[16:31]
  ds_read_b128 v[168:171], v4 offset:30624
  ds_read_b64_tr_b16 v[172:173], v6 offset:28672
  ds_read_b64_tr_b16 v[174:175], v6 offset:29184
  v_max3_f32 v220, |v53|, |v54|, v220
  v_max3_f32 v220, |v55|, |v56|, v220
  v_mfma_f32_32x32x16_bf16 v[16:31], v[116:119], v[112:115], v[16:31]
  ds_read_b128 v[176:179], v4 offset:31680
  ds_read_b64_tr_b16 v[180:181], v6 offset:30720
  ds_read_b64_tr_b16 v[182:183], v6 offset:31232
  v_max3_f32 v220, |v57|, |v58|, v220
  v_max3_f32 v220, |v59|, |v60|, v220
  v_mfma_f32_32x32x16_bf16 v[16:31], v[124:127], v[120:123], v[16:31]
  ds_read_b128 v[184:187], v4 offset:32736
  ds_read_b64_tr_b16 v[188:189], v6 offset:32768
  ds_read_b64_tr_b16 v[190:191], v6 offset:33280
  v_max3_f32 v220, |v61|, |v62|, v220
  v_max_f32 v220, |v63|, v220
  s_waitcnt lgkmcnt(0)
  v_mfma_f32_32x32x16_bf16 v[16:31], v[132:135], v[128:131], v[16:31]
  v_mfma_f32_32x32x16_bf16 v[16:31], v[140:143], v[136:139], v[16:31]
  v_mfma_f32_32x32x16_bf16 v[16:31], v[148:151], v[144:147], v[16:31]
  v_mfma_f32_32x32x16_bf16 v[16:31], v[156:159], v[152:155], v[16:31]
  v_mfma_f32_32x32x16_bf16 v[16:31], v[164:167], v[160:163], v[16:31]
  v_mfma_f32_32x32x16_bf16 v[16:31], v[172:175], v[168:171], v[16:31]
  v_mfma_f32_32x32x16_bf16 v[16:31], v[180:183], v[176:179], v[16:31]
  v_mfma_f32_32x32x16_bf16 v[16:31], v[188:191], v[184:187], v[16:31]
  s_nop 15
  v_pk_mul_f32 v[16:17], v[16:17], s[42:43] op_sel_hi:[1,0]
  v_pk_mul_f32 v[18:19], v[18:19], s[42:43] op_sel_hi:[1,0]
  v_pk_mul_f32 v[20:21], v[20:21], s[42:43] op_sel_hi:[1,0]
  v_pk_mul_f32 v[22:23], v[22:23], s[42:43] op_sel_hi:[1,0]
  v_pk_mul_f32 v[24:25], v[24:25], s[42:43] op_sel_hi:[1,0]
  v_pk_mul_f32 v[26:27], v[26:27], s[42:43] op_sel_hi:[1,0]
  v_pk_mul_f32 v[28:29], v[28:29], s[42:43] op_sel_hi:[1,0]
  v_pk_mul_f32 v[30:31], v[30:31], s[42:43] op_sel_hi:[1,0]
  v_cvt_pk_bf16_f32 v208, v16, v17
  v_cvt_pk_bf16_f32 v209, v18, v19
  v_cvt_pk_bf16_f32 v210, v20, v21
  v_cvt_pk_bf16_f32 v211, v22, v23
  s_add_u32 s43, s40, 0
  buffer_store_dwordx4 v[208:211], v8, s[16:19], s43 offen sc1
  v_cvt_pk_bf16_f32 v212, v24, v25
  v_cvt_pk_bf16_f32 v213, v26, v27
  v_cvt_pk_bf16_f32 v214, v28, v29
  v_cvt_pk_bf16_f32 v215, v30, v31
  s_add_u32 s43, s40, 65536
  buffer_store_dwordx4 v[212:215], v8, s[16:19], s43 offen sc1
  v_mul_f32 v216, v16, v16
  v_mul_f32 v217, v24, v24
  v_fmac_f32 v216, v17, v17
  v_fmac_f32 v217, v25, v25
  v_fmac_f32 v216, v18, v18
  v_fmac_f32 v217, v26, v26
  v_fmac_f32 v216, v19, v19
  v_fmac_f32 v217, v27, v27
  v_fmac_f32 v216, v20, v20
  v_fmac_f32 v217, v28, v28
  v_fmac_f32 v216, v21, v21
  v_fmac_f32 v217, v29, v29
  v_fmac_f32 v216, v22, v22
  v_fmac_f32 v217, v30, v30
  v_fmac_f32 v216, v23, v23
  v_fmac_f32 v217, v31, v31
  v_mov_b32 v72, v216
  v_mov_b32 v73, v217
  v_mov_b32 v74, v218
  v_mov_b32 v75, v219
  s_nop 1
  v_permlane32_swap_b32 v216, v72
  v_permlane32_swap_b32 v217, v73
  v_permlane32_swap_b32 v218, v74
  v_permlane32_swap_b32 v219, v75
  s_nop 1
  v_add_f32 v216, v216, v72
  v_add_f32 v217, v217, v73
  v_add_f32 v218, v218, v74
  v_add_f32 v219, v219, v75
  v_max_f32_dpp v216, v216, v216 quad_perm:[1,0,3,2] row_mask:0xf bank_mask:0xf
  v_max_f32_dpp v217, v217, v217 quad_perm:[1,0,3,2] row_mask:0xf bank_mask:0xf
  v_max_f32_dpp v218, v218, v218 quad_perm:[1,0,3,2] row_mask:0xf bank_mask:0xf
  v_max_f32_dpp v219, v219, v219 quad_perm:[1,0,3,2] row_mask:0xf bank_mask:0xf
  v_max_f32_dpp v220, v220, v220 quad_perm:[1,0,3,2] row_mask:0xf bank_mask:0xf
  v_max_f32_dpp v216, v216, v216 quad_perm:[2,3,0,1] row_mask:0xf bank_mask:0xf
  v_max_f32_dpp v217, v217, v217 quad_perm:[2,3,0,1] row_mask:0xf bank_mask:0xf
  v_max_f32_dpp v218, v218, v218 quad_perm:[2,3,0,1] row_mask:0xf bank_mask:0xf
  v_max_f32_dpp v219, v219, v219 quad_perm:[2,3,0,1] row_mask:0xf bank_mask:0xf
  v_max_f32_dpp v220, v220, v220 quad_perm:[2,3,0,1] row_mask:0xf bank_mask:0xf
  v_max_f32_dpp v216, v216, v216 row_half_mirror row_mask:0xf bank_mask:0xf
  v_max_f32_dpp v217, v217, v217 row_half_mirror row_mask:0xf bank_mask:0xf
  v_max_f32_dpp v218, v218, v218 row_half_mirror row_mask:0xf bank_mask:0xf
  v_max_f32_dpp v219, v219, v219 row_half_mirror row_mask:0xf bank_mask:0xf
  v_max_f32_dpp v220, v220, v220 row_half_mirror row_mask:0xf bank_mask:0xf
  v_max_f32_dpp v216, v216, v216 row_mirror row_mask:0xf bank_mask:0xf
  v_max_f32_dpp v217, v217, v217 row_mirror row_mask:0xf bank_mask:0xf
  v_max_f32_dpp v218, v218, v218 row_mirror row_mask:0xf bank_mask:0xf
  v_max_f32_dpp v219, v219, v219 row_mirror row_mask:0xf bank_mask:0xf
  v_max_f32_dpp v220, v220, v220 row_mirror row_mask:0xf bank_mask:0xf
  v_mov_b32 v72, v216
  v_mov_b32 v73, v217
  v_mov_b32 v74, v218
  v_mov_b32 v75, v219
  v_mov_b32 v76, v220
  s_nop 1
  v_permlane16_swap_b32 v216, v72
  v_permlane16_swap_b32 v217, v73
  v_permlane16_swap_b32 v218, v74
  v_permlane16_swap_b32 v219, v75
  v_permlane16_swap_b32 v220, v76
  s_nop 1
  v_max_f32 v216, v216, v72
  v_max_f32 v217, v217, v73
  v_max_f32 v218, v218, v74
  v_max_f32 v219, v219, v75
  v_max_f32 v220, v220, v76
  v_mov_b32 v76, v220
  s_nop 1
  v_permlane32_swap_b32 v220, v76
  s_nop 1
  v_max_f32 v220, v220, v76
  s_mov_b32 s44, 0x53800000
  v_cmp_nle_f32 vcc, v220, s44
  v_mov_b32 v76, 0x7f800000
  s_lshr_b32 s46, s39, 1
  s_lshl_b32 s45, s46, 6
  v_cndmask_b32 v218, v218, v76, vcc
  v_cndmask_b32 v219, v219, v76, vcc
  s_add_u32 s45, s45, s38
  s_lshl_b32 s45, s45, 4
  v_mov_b32 v77, 0
  s_mov_b64 exec, 1
  buffer_store_dwordx4 v[216:219], v77, s[20:23], s45 offen sc1
  s_mov_b64 exec, -1
  s_waitcnt vmcnt(7)
  v_readfirstlane_b32 s86, v249
  s_nop 3
  s_cmp_lg_u32 s86, 0
  s_cbranch_scc1 NF_L_1_ok
  s_mov_b32 s48, s82
  s_and_b32 s49, s83, 0xffff
  s_mov_b32 s50, 256
  s_mov_b32 s51, 0x20000
  v_mov_b32 v250, 0
  s_mov_b32 s47, 200000
NF_L_1:
  buffer_load_dword v251, v250, s[48:51], 0 offen sc1
  s_waitcnt vmcnt(0)
  v_readfirstlane_b32 s86, v251
  s_nop 3
  s_cmp_lg_u32 s86, 0
  s_cbranch_scc1 NF_L_1_ok
  s_sub_u32 s47, s47, 1
  s_cmp_eq_u32 s47, 0
  s_cbranch_scc1 NF_L_1_ok
  s_sleep 1
  s_branch NF_L_1
NF_L_1_ok:
  s_lshl_b32 s33, s26, 5
  s_add_u32 s33, s33, s25
  s_add_u32 s48, s84, 23068672
  s_addc_u32 s49, s85, 0
  s_and_b32 s49, s49, 0xffff
  s_mov_b32 s50, 135168
  s_mov_b32 s51, 0x20000
  s_add_u32 s46, s33, 0
  s_lshl_b32 s46, s46, 7
  v_mov_b32 v250, 163776
  v_mov_b32 v251, 1
  v_mov_b32 v253, s86
  v_mov_b32 v254, 0
  s_waitcnt vmcnt(0)
  s_mov_b64 exec, 1
  ds_add_rtn_u32 v251, v250, v251
  s_waitcnt lgkmcnt(0)
  v_readfirstlane_b32 s47, v251
  s_nop 3
  s_cmp_lg_u32 s47, 3
  s_cbranch_scc1 P1_arr_L_2
  buffer_store_dword v253, v254, s[48:51], s46 offen sc1
P1_arr_L_2:
  s_mov_b64 exec, -1
  s_branch P1_join
P1_prod:
  v_mul_u32_u24 v20, 43, v1
  v_lshrrev_b32 v20, 7, v20
  v_mul_u32_u24 v21, 3, v20
  v_sub_u32 v21, v1, v21
  s_and_b32 s38, s25, 7
  s_lshl_b32 s38, s38, 2
  s_add_u32 s38, s38, s29
  s_lshl_b32 s38, s38, 4
  v_add_u32 v20, s38, v20
  v_mul_u32_u24 v20, 3072, v20
  v_lshl_add_u32 v20, v21, 10, v20
  s_lshl_b32 s38, s26, 7
  s_mov_b32 exec_hi, 0xffff
  buffer_load_dword v252, v20, s[12:15], s38 offen
  s_mov_b64 exec, -1
  s_getpc_b64 s[52:53]
PF_anchor:
  s_sub_u32 s52, s52, (PF_anchor - sequential_preLN__softmax_full_mha__dense_activation_gelu__prompt_kernel)
  s_subb_u32 s53, s53, 0
  s_lshr_b32 s38, s2, 3
  s_lshl_b32 s38, s38, 2
  s_add_u32 s38, s38, s29
  s_mul_i32 s38, s38, 384
  v_lshlrev_b32 v20, 7, v1
  v_add_u32 v20, s38, v20
  v_min_u32 v20, (E_end - sequential_preLN__softmax_full_mha__dense_activation_gelu__prompt_kernel), v20
  v_mov_b32 v21, s53
  v_add_co_u32 v20, vcc, s52, v20
  s_nop 1
  v_addc_co_u32 v21, vcc, 0, v21, vcc
  s_mov_b64 exec, 7
  global_load_dword v252, v[20:21], off
  s_mov_b64 exec, -1
  v_mov_b32 v8, 0
  v_mov_b32 v9, 0
  v_mov_b32 v10, 0
  v_mov_b32 v11, 0
  s_waitcnt vmcnt(8)
  v_dot2c_f32_bf16 v8, s35, v64
  v_dot2c_f32_bf16 v9, v64, v64
  v_dot2c_f32_bf16 v10, s35, v65
  v_dot2c_f32_bf16 v11, v65, v65
  v_dot2c_f32_bf16 v8, s35, v66
  v_dot2c_f32_bf16 v9, v66, v66
  v_dot2c_f32_bf16 v10, s35, v67
  v_dot2c_f32_bf16 v11, v67, v67
  v_dot2c_f32_bf16 v8, s35, v68
  v_dot2c_f32_bf16 v9, v68, v68
  v_dot2c_f32_bf16 v10, s35, v69
  v_dot2c_f32_bf16 v11, v69, v69
  v_dot2c_f32_bf16 v8, s35, v70
  v_dot2c_f32_bf16 v9, v70, v70
  v_dot2c_f32_bf16 v10, s35, v71
  v_dot2c_f32_bf16 v11, v71, v71
  s_waitcnt vmcnt(6)
  v_dot2c_f32_bf16 v8, s35, v72
  v_dot2c_f32_bf16 v9, v72, v72
  v_dot2c_f32_bf16 v10, s35, v73
  v_dot2c_f32_bf16 v11, v73, v73
  v_dot2c_f32_bf16 v8, s35, v74
  v_dot2c_f32_bf16 v9, v74, v74
  v_dot2c_f32_bf16 v10, s35, v75
  v_dot2c_f32_bf16 v11, v75, v75
  v_dot2c_f32_bf16 v8, s35, v76
  v_dot2c_f32_bf16 v9, v76, v76
  v_dot2c_f32_bf16 v10, s35, v77
  v_dot2c_f32_bf16 v11, v77, v77
  v_dot2c_f32_bf16 v8, s35, v78
  v_dot2c_f32_bf16 v9, v78, v78
  v_dot2c_f32_bf16 v10, s35, v79
  v_dot2c_f32_bf16 v11, v79, v79
  s_waitcnt vmcnt(4)
  v_dot2c_f32_bf16 v8, s35, v80
  v_dot2c_f32_bf16 v9, v80, v80
  v_dot2c_f32_bf16 v10, s35, v81
  v_dot2c_f32_bf16 v11, v81, v81
  v_dot2c_f32_bf16 v8, s35, v82
  v_dot2c_f32_bf16 v9, v82, v82
  v_dot2c_f32_bf16 v10, s35, v83
  v_dot2c_f32_bf16 v11, v83, v83
  v_dot2c_f32_bf16 v8, s35, v84
  v_dot2c_f32_bf16 v9, v84, v84
  v_dot2c_f32_bf16 v10, s35, v85
  v_dot2c_f32_bf16 v11, v85, v85
  v_dot2c_f32_bf16 v8, s35, v86
  v_dot2c_f32_bf16 v9, v86, v86
  v_dot2c_f32_bf16 v10, s35, v87
  v_dot2c_f32_bf16 v11, v87, v87
  s_waitcnt vmcnt(2)
  v_dot2c_f32_bf16 v8, s35, v88
  v_dot2c_f32_bf16 v9, v88, v88
  v_dot2c_f32_bf16 v10, s35, v89
  v_dot2c_f32_bf16 v11, v89, v89
  v_dot2c_f32_bf16 v8, s35, v90
  v_dot2c_f32_bf16 v9, v90, v90
  v_dot2c_f32_bf16 v10, s35, v91
  v_dot2c_f32_bf16 v11, v91, v91
  v_dot2c_f32_bf16 v8, s35, v92
  v_dot2c_f32_bf16 v9, v92, v92
  v_dot2c_f32_bf16 v10, s35, v93
  v_dot2c_f32_bf16 v11, v93, v93
  v_dot2c_f32_bf16 v8, s35, v94
  v_dot2c_f32_bf16 v9, v94, v94
  v_dot2c_f32_bf16 v10, s35, v95
  v_dot2c_f32_bf16 v11, v95, v95
  s_nop 2
  v_add_f32 v8, v8, v10
  v_add_f32 v9, v9, v11
  s_nop 0
  s_nop 0
  v_add_f32_dpp v8, v8, v8 quad_perm:[1,0,3,2] row_mask:0xf bank_mask:0xf
  v_add_f32_dpp v9, v9, v9 quad_perm:[1,0,3,2] row_mask:0xf bank_mask:0xf
  s_nop 0
  v_add_f32_dpp v8, v8, v8 quad_perm:[2,3,0,1] row_mask:0xf bank_mask:0xf
  v_add_f32_dpp v9, v9, v9 quad_perm:[2,3,0,1] row_mask:0xf bank_mask:0xf
  s_nop 0
  v_add_f32_dpp v8, v8, v8 row_half_mirror row_mask:0xf bank_mask:0xf
  v_add_f32_dpp v9, v9, v9 row_half_mirror row_mask:0xf bank_mask:0xf
  v_mul_f32 v8, 0x3b000000, v8
  v_mul_f32 v9, 0x3b000000, v9
  v_fma_f32 v9, -v8, v8, v9
  v_max_f32 v9, 0, v9
  v_add_f32 v9, 0x3727c5ac, v9
  v_rsq_f32 v10, v9
  s_nop 0
  v_mul_f32 v8, v8, v10
  v_sub_f32 v8, 0, v8
  v_mov_b32 v11, v10
  v_mov_b32 v9, v8
  v_lshlrev_b32 v16, 16, v64
  v_and_b32 v17, 0xffff0000, v64
  v_lshlrev_b32 v18, 16, v65
  v_and_b32 v19, 0xffff0000, v65
  v_lshlrev_b32 v20, 16, v66
  v_and_b32 v21, 0xffff0000, v66
  v_lshlrev_b32 v22, 16, v67
  v_and_b32 v23, 0xffff0000, v67
  v_pk_fma_f32 v[16:17], v[16:17], v[10:11], v[8:9]
  v_pk_fma_f32 v[18:19], v[18:19], v[10:11], v[8:9]
  v_pk_fma_f32 v[20:21], v[20:21], v[10:11], v[8:9]
  v_pk_fma_f32 v[22:23], v[22:23], v[10:11], v[8:9]
  v_cvt_pk_bf16_f32 v64, v16, v17
  v_cvt_pk_bf16_f32 v65, v18, v19
  v_cvt_pk_bf16_f32 v66, v20, v21
  v_cvt_pk_bf16_f32 v67, v22, v23
  ds_write_b128 v12, v[64:67] offset:0
  v_lshlrev_b32 v16, 16, v68
  v_and_b32 v17, 0xffff0000, v68
  v_lshlrev_b32 v18, 16, v69
  v_and_b32 v19, 0xffff0000, v69
  v_lshlrev_b32 v20, 16, v70
  v_and_b32 v21, 0xffff0000, v70
  v_lshlrev_b32 v22, 16, v71
  v_and_b32 v23, 0xffff0000, v71
  v_pk_fma_f32 v[16:17], v[16:17], v[10:11], v[8:9]
  v_pk_fma_f32 v[18:19], v[18:19], v[10:11], v[8:9]
  v_pk_fma_f32 v[20:21], v[20:21], v[10:11], v[8:9]
  v_pk_fma_f32 v[22:23], v[22:23], v[10:11], v[8:9]
  v_cvt_pk_bf16_f32 v68, v16, v17
  v_cvt_pk_bf16_f32 v69, v18, v19
  v_cvt_pk_bf16_f32 v70, v20, v21
  v_cvt_pk_bf16_f32 v71, v22, v23
  ds_write_b128 v12, v[68:71] offset:4224
  v_lshlrev_b32 v16, 16, v72
  v_and_b32 v17, 0xffff0000, v72
  v_lshlrev_b32 v18, 16, v73
  v_and_b32 v19, 0xffff0000, v73
  v_lshlrev_b32 v20, 16, v74
  v_and_b32 v21, 0xffff0000, v74
  v_lshlrev_b32 v22, 16, v75
  v_and_b32 v23, 0xffff0000, v75
  v_pk_fma_f32 v[16:17], v[16:17], v[10:11], v[8:9]
  v_pk_fma_f32 v[18:19], v[18:19], v[10:11], v[8:9]
  v_pk_fma_f32 v[20:21], v[20:21], v[10:11], v[8:9]
  v_pk_fma_f32 v[22:23], v[22:23], v[10:11], v[8:9]
  v_cvt_pk_bf16_f32 v72, v16, v17
  v_cvt_pk_bf16_f32 v73, v18, v19
  v_cvt_pk_bf16_f32 v74, v20, v21
  v_cvt_pk_bf16_f32 v75, v22, v23
  ds_write_b128 v12, v[72:75] offset:8448
  v_lshlrev_b32 v16, 16, v76
  v_and_b32 v17, 0xffff0000, v76
  v_lshlrev_b32 v18, 16, v77
  v_and_b32 v19, 0xffff0000, v77
  v_lshlrev_b32 v20, 16, v78
  v_and_b32 v21, 0xffff0000, v78
  v_lshlrev_b32 v22, 16, v79
  v_and_b32 v23, 0xffff0000, v79
  v_pk_fma_f32 v[16:17], v[16:17], v[10:11], v[8:9]
  v_pk_fma_f32 v[18:19], v[18:19], v[10:11], v[8:9]
  v_pk_fma_f32 v[20:21], v[20:21], v[10:11], v[8:9]
  v_pk_fma_f32 v[22:23], v[22:23], v[10:11], v[8:9]
  v_cvt_pk_bf16_f32 v76, v16, v17
  v_cvt_pk_bf16_f32 v77, v18, v19
  v_cvt_pk_bf16_f32 v78, v20, v21
  v_cvt_pk_bf16_f32 v79, v22, v23
  ds_write_b128 v12, v[76:79] offset:12672
  v_lshlrev_b32 v16, 16, v80
  v_and_b32 v17, 0xffff0000, v80
  v_lshlrev_b32 v18, 16, v81
  v_and_b32 v19, 0xffff0000, v81
  v_lshlrev_b32 v20, 16, v82
  v_and_b32 v21, 0xffff0000, v82
  v_lshlrev_b32 v22, 16, v83
  v_and_b32 v23, 0xffff0000, v83
  v_pk_fma_f32 v[16:17], v[16:17], v[10:11], v[8:9]
  v_pk_fma_f32 v[18:19], v[18:19], v[10:11], v[8:9]
  v_pk_fma_f32 v[20:21], v[20:21], v[10:11], v[8:9]
  v_pk_fma_f32 v[22:23], v[22:23], v[10:11], v[8:9]
  v_cvt_pk_bf16_f32 v80, v16, v17
  v_cvt_pk_bf16_f32 v81, v18, v19
  v_cvt_pk_bf16_f32 v82, v20, v21
  v_cvt_pk_bf16_f32 v83, v22, v23
  ds_write_b128 v12, v[80:83] offset:16896
  v_lshlrev_b32 v16, 16, v84
  v_and_b32 v17, 0xffff0000, v84
  v_lshlrev_b32 v18, 16, v85
  v_and_b32 v19, 0xffff0000, v85
  v_lshlrev_b32 v20, 16, v86
  v_and_b32 v21, 0xffff0000, v86
  v_lshlrev_b32 v22, 16, v87
  v_and_b32 v23, 0xffff0000, v87
  v_pk_fma_f32 v[16:17], v[16:17], v[10:11], v[8:9]
  v_pk_fma_f32 v[18:19], v[18:19], v[10:11], v[8:9]
  v_pk_fma_f32 v[20:21], v[20:21], v[10:11], v[8:9]
  v_pk_fma_f32 v[22:23], v[22:23], v[10:11], v[8:9]
  v_cvt_pk_bf16_f32 v84, v16, v17
  v_cvt_pk_bf16_f32 v85, v18, v19
  v_cvt_pk_bf16_f32 v86, v20, v21
  v_cvt_pk_bf16_f32 v87, v22, v23
  ds_write_b128 v12, v[84:87] offset:21120
  v_lshlrev_b32 v16, 16, v88
  v_and_b32 v17, 0xffff0000, v88
  v_lshlrev_b32 v18, 16, v89
  v_and_b32 v19, 0xffff0000, v89
  v_lshlrev_b32 v20, 16, v90
  v_and_b32 v21, 0xffff0000, v90
  v_lshlrev_b32 v22, 16, v91
  v_and_b32 v23, 0xffff0000, v91
  v_pk_fma_f32 v[16:17], v[16:17], v[10:11], v[8:9]
  v_pk_fma_f32 v[18:19], v[18:19], v[10:11], v[8:9]
  v_pk_fma_f32 v[20:21], v[20:21], v[10:11], v[8:9]
  v_pk_fma_f32 v[22:23], v[22:23], v[10:11], v[8:9]
  v_cvt_pk_bf16_f32 v88, v16, v17
  v_cvt_pk_bf16_f32 v89, v18, v19
  v_cvt_pk_bf16_f32 v90, v20, v21
  v_cvt_pk_bf16_f32 v91, v22, v23
  ds_write_b128 v12, v[88:91] offset:25344
  v_lshlrev_b32 v16, 16, v92
  v_and_b32 v17, 0xffff0000, v92
  v_lshlrev_b32 v18, 16, v93
  v_and_b32 v19, 0xffff0000, v93
  v_lshlrev_b32 v20, 16, v94
  v_and_b32 v21, 0xffff0000, v94
  v_lshlrev_b32 v22, 16, v95
  v_and_b32 v23, 0xffff0000, v95
  v_pk_fma_f32 v[16:17], v[16:17], v[10:11], v[8:9]
  v_pk_fma_f32 v[18:19], v[18:19], v[10:11], v[8:9]
  v_pk_fma_f32 v[20:21], v[20:21], v[10:11], v[8:9]
  v_pk_fma_f32 v[22:23], v[22:23], v[10:11], v[8:9]
  v_cvt_pk_bf16_f32 v92, v16, v17
  v_cvt_pk_bf16_f32 v93, v18, v19
  v_cvt_pk_bf16_f32 v94, v20, v21
  v_cvt_pk_bf16_f32 v95, v22, v23
  ds_write_b128 v12, v[92:95] offset:29568
  s_mov_b32 s48, s82
  s_and_b32 s49, s83, 0xffff
  s_mov_b32 s50, 256
  s_mov_b32 s51, 0x20000
  v_mov_b32 v250, 0
  buffer_load_dword v249, v250, s[48:51], 0 offen sc1
  s_waitcnt lgkmcnt(0)
  s_barrier
  s_add_u32 m0, s37, 116736
  s_add_u32 s36, s34, 590848
  buffer_load_dwordx4 v4, s[12:15], s36 offen lds
  buffer_load_dwordx4 v13, s[12:15], s36 offen offset:1024 lds
  s_add_u32 m0, s37, 124928
  s_add_u32 s36, s34, 591872
  buffer_load_dwordx4 v4, s[12:15], s36 offen lds
  buffer_load_dwordx4 v13, s[12:15], s36 offen offset:1024 lds
  s_add_u32 m0, s37, 133120
  s_add_u32 s36, s34, 787456
  buffer_load_dwordx4 v4, s[12:15], s36 offen lds
  buffer_load_dwordx4 v13, s[12:15], s36 offen offset:1024 lds
  s_add_u32 m0, s37, 141312
  s_add_u32 s36, s34, 788480
  buffer_load_dwordx4 v4, s[12:15], s36 offen lds
  buffer_load_dwordx4 v13, s[12:15], s36 offen offset:1024 lds
  s_barrier
  s_barrier
  s_barrier
  s_add_u32 m0, s37, 67584
  s_add_u32 s36, s34, 984064
  buffer_load_dwordx4 v4, s[12:15], s36 offen lds
  buffer_load_dwordx4 v13, s[12:15], s36 offen offset:1024 lds
  s_add_u32 m0, s37, 75776
  s_add_u32 s36, s34, 985088
  buffer_load_dwordx4 v4, s[12:15], s36 offen lds
  buffer_load_dwordx4 v13, s[12:15], s36 offen offset:1024 lds
  s_waitcnt vmcnt(8)
  s_barrier
  s_add_u32 m0, s37, 83968
  s_add_u32 s36, s34, 1180672
  buffer_load_dwordx4 v4, s[12:15], s36 offen lds
  buffer_load_dwordx4 v13, s[12:15], s36 offen offset:1024 lds
  s_add_u32 m0, s37, 92160
  s_add_u32 s36, s34, 1181696
  buffer_load_dwordx4 v4, s[12:15], s36 offen lds
  buffer_load_dwordx4 v13, s[12:15], s36 offen offset:1024 lds
  s_waitcnt vmcnt(8)
  s_barrier
  s_add_u32 m0, s37, 100352
  s_add_u32 s36, s34, 1377280
  buffer_load_dwordx4 v4, s[12:15], s36 offen lds
  buffer_load_dwordx4 v13, s[12:15], s36 offen offset:1024 lds
  s_add_u32 m0, s37, 108544
  s_add_u32 s36, s34, 1378304
  buffer_load_dwordx4 v4, s[12:15], s36 offen lds
  buffer_load_dwordx4 v13, s[12:15], s36 offen offset:1024 lds
  s_waitcnt vmcnt(8)
  s_barrier
  s_add_u32 m0, s37, 116736
  s_add_u32 s36, s34, 0
  buffer_load_dwordx4 v4, s[12:15], s36 offen lds
  buffer_load_dwordx4 v13, s[12:15], s36 offen offset:1024 lds
  s_add_u32 m0, s37, 124928
  s_add_u32 s36, s34, 196608
  buffer_load_dwordx4 v4, s[12:15], s36 offen lds
  buffer_load_dwordx4 v13, s[12:15], s36 offen offset:1024 lds
  s_waitcnt vmcnt(8)
  s_barrier
  s_add_u32 m0, s37, 133120
  s_add_u32 s36, s34, 393216
  buffer_load_dwordx4 v4, s[12:15], s36 offen lds
  buffer_load_dwordx4 v13, s[12:15], s36 offen offset:1024 lds
  s_add_u32 m0, s37, 141312
  s_add_u32 s36, s34, 589824
  buffer_load_dwordx4 v4, s[12:15], s36 offen lds
  buffer_load_dwordx4 v13, s[12:15], s36 offen offset:1024 lds
  s_waitcnt vmcnt(8)
  s_barrier
  s_add_u32 m0, s37, 67584
  s_add_u32 s36, s34, 786432
  buffer_load_dwordx4 v4, s[12:15], s36 offen lds
  buffer_load_dwordx4 v13, s[12:15], s36 offen offset:1024 lds
  s_add_u32 m0, s37, 75776
  s_add_u32 s36, s34, 983040
  buffer_load_dwordx4 v4, s[12:15], s36 offen lds
  buffer_load_dwordx4 v13, s[12:15], s36 offen offset:1024 lds
  s_waitcnt vmcnt(8)
  s_barrier
  s_add_u32 m0, s37, 83968
  s_add_u32 s36, s34, 1179648
  buffer_load_dwordx4 v4, s[12:15], s36 offen lds
  buffer_load_dwordx4 v13, s[12:15], s36 offen offset:1024 lds
  s_add_u32 m0, s37, 92160
  s_add_u32 s36, s34, 1376256
  buffer_load_dwordx4 v4, s[12:15], s36 offen lds
  buffer_load_dwordx4 v13, s[12:15], s36 offen offset:1024 lds
  s_waitcnt vmcnt(8)
  s_barrier
  s_waitcnt vmcnt(4)
  s_barrier
  s_waitcnt vmcnt(0)
  s_barrier
  v_readfirstlane_b32 s86, v249
  s_nop 3
  s_cmp_lg_u32 s86, 0
  s_cbranch_scc1 NF_L_3_ok
  s_mov_b32 s48, s82
  s_and_b32 s49, s83, 0xffff
  s_mov_b32 s50, 256
  s_mov_b32 s51, 0x20000
  v_mov_b32 v250, 0
  s_mov_b32 s47, 200000
NF_L_3:
  buffer_load_dword v251, v250, s[48:51], 0 offen sc1
  s_waitcnt vmcnt(0)
  v_readfirstlane_b32 s86, v251
  s_nop 3
  s_cmp_lg_u32 s86, 0
  s_cbranch_scc1 NF_L_3_ok
  s_sub_u32 s47, s47, 1
  s_cmp_eq_u32 s47, 0
  s_cbranch_scc1 NF_L_3_ok
  s_sleep 1
  s_branch NF_L_3
NF_L_3_ok:
P1_join:
  s_and_b32 s27, s2, 7
  s_lshr_b32 s28, s2, 3
  s_lshr_b32 s25, s28, 3
  s_lshl_b32 s26, s27, 2
  s_add_u32 s25, s25, s26
  s_and_b32 s26, s28, 7
  v_lshlrev_b32 v2, 4, v1
  s_lshl_b32 s29, s25, 16
  s_and_b32 s37, s24, 3
  s_lshr_b32 s38, s24, 2
  s_lshl_b32 s30, s26, 3
  s_lshl_b32 s31, s37, 1
  s_add_u32 s30, s30, s31
  s_lshl_b32 s31, s30, 10
  s_add_u32 s31, s31, s29
  s_lshl_b32 s34, s24, 10
  s_add_u32 s35, s29, s34
  v_mov_b32 v136, 0xdddddddd
  s_lshl_b32 s39, s38, 15
  v_add_u32 v137, s39, v2
  v_lshrrev_b32 v14, 5, v1
  v_lshlrev_b32 v14, 8, v14
  v_and_b32 v15, 15, v1
  v_lshl_add_u32 v14, v15, 4, v14
  s_add_u32 s39, s39, 0x10000
  v_add_u32 v138, s39, v14
  v_and_b32 v14, 27, v1
  v_cmp_eq_u32 vcc, 16, v14
  v_mov_b32 v15, 0x3f803f80
  v_mov_b32 v14, 0
  v_cndmask_b32 v14, v14, v15, vcc
  v_mov_b32 v24, v14
  v_mov_b32 v25, v14
  v_mov_b32 v26, v14
  v_mov_b32 v27, v14
  v_mov_b32 v28, v14
  v_mov_b32 v29, v14
  v_mov_b32 v30, v14
  v_mov_b32 v31, v14
  v_mov_b32 v32, v14
  v_mov_b32 v33, v14
  v_mov_b32 v34, v14
  v_mov_b32 v35, v14
  v_mov_b32 v36, v14
  v_mov_b32 v37, v14
  v_mov_b32 v38, v14
  v_mov_b32 v39, v14
  v_mov_b32 v72, 0
  v_mov_b32 v73, 0
  v_mov_b32 v74, 0
  v_mov_b32 v75, 0
  v_mov_b32 v76, 0
  v_mov_b32 v77, 0
  v_mov_b32 v78, 0
  v_mov_b32 v79, 0
  v_mov_b32 v80, 0
  v_mov_b32 v81, 0
  v_mov_b32 v82, 0
  v_mov_b32 v83, 0
  v_mov_b32 v84, 0
  v_mov_b32 v85, 0
  v_mov_b32 v86, 0
  v_mov_b32 v87, 0
  v_mov_b32 v88, 0
  v_mov_b32 v89, 0
  v_mov_b32 v90, 0
  v_mov_b32 v91, 0
  v_mov_b32 v92, 0
  v_mov_b32 v93, 0
  v_mov_b32 v94, 0
  v_mov_b32 v95, 0
  v_mov_b32 v96, 0
  v_mov_b32 v97, 0
  v_mov_b32 v98, 0
  v_mov_b32 v99, 0
  v_mov_b32 v100, 0
  v_mov_b32 v101, 0
  v_mov_b32 v102, 0
  v_mov_b32 v103, 0
  s_mov_b32 s40, 0x0000ffff
  s_mov_b32 s41, 0x0000ffff
  s_add_u32 s8, s84, 2097152
  s_addc_u32 s9, s85, 0
  s_and_b32 s9, s9, 0xffff
  s_mov_b32 s10, 6291456
  s_mov_b32 s11, 0x20000
  s_add_u32 s16, s84, 21102592
  s_addc_u32 s17, s85, 0
  s_and_b32 s17, s17, 0xffff
  s_mov_b32 s18, 16384
  s_mov_b32 s19, 0x20000
  s_add_u32 s12, s84, 8388608
  s_addc_u32 s13, s85, 0
  s_and_b32 s13, s13, 0xffff
  s_mov_b32 s14, 2097152
  s_mov_b32 s15, 0x20000
  s_cmp_lg_u32 s24, 7
  s_cbranch_scc1 P2np_L_4
  v_mov_b32 v250, 163776
  s_mov_b32 s47, 100000
P2_lw:
  ds_read_b32 v251, v250
  s_waitcnt lgkmcnt(0)
  v_readfirstlane_b32 s46, v251
  s_sub_u32 s47, s47, 1
  s_cmp_eq_u32 s47, 0
  s_cbranch_scc1 P2_lw_ok
  s_sleep 2
  s_cmp_lt_u32 s46, 4
  s_cbranch_scc1 P2_lw
P2_lw_ok:
  s_lshr_b32 s33, s25, 2
  s_lshl_b32 s33, s33, 5
  s_add_u32 s48, s84, 23068672
  s_addc_u32 s49, s85, 0
  s_and_b32 s49, s49, 0xffff
  s_mov_b32 s50, 135168
  s_mov_b32 s51, 0x20000
  s_add_u32 s46, s33, 0
  s_lshl_b32 s46, s46, 7
  v_lshlrev_b32 v250, 7, v1
  s_mov_b32 s47, 100000
  s_mov_b64 exec, 0xffffffff
  s_waitcnt vmcnt(0)
  buffer_load_dword v251, v250, s[48:51], s46 offen sc1
  s_sleep 4
P2_poll_L_5:
  buffer_load_dword v253, v250, s[48:51], s46 offen sc1
  s_waitcnt vmcnt(1)
  v_cmp_ne_u32 vcc, s86, v251
  s_nop 4
  s_and_b64 exec, exec, vcc
  s_cbranch_execz P2_poll_L_5_ok
  buffer_load_dword v251, v250, s[48:51], s46 offen sc1
  s_waitcnt vmcnt(1)
  v_cmp_ne_u32 vcc, s86, v253
  s_nop 4
  s_and_b64 exec, exec, vcc
  s_cbranch_execz P2_poll_L_5_ok
  s_sub_u32 s47, s47, 1
  s_cmp_eq_u32 s47, 0
  s_cbranch_scc0 P2_poll_L_5
P2_poll_L_5_ok:
  s_mov_b64 exec, -1
P2np_L_4:
  s_barrier
  s_lshr_b32 s32, s25, 1
  s_lshl_b32 s32, s32, 10
  s_and_b32 s33, s25, 1
  s_lshl_b32 s33, s33, 2
  s_add_u32 s32, s32, s33
  buffer_load_dword v12, v2, s[16:19], s32 offen offset:8 sc1
  v_and_b32 v3, 7, v1
  v_lshlrev_b32 v3, 4, v3
  s_lshl_b32 s33, s26, 7
  s_add_u32 s33, s33, s32
  buffer_load_dword v13, v3, s[16:19], s33 offen sc1
  s_add_u32 m0, s34, 0
  s_add_u32 s36, s35, 2097152
  buffer_load_dwordx4 v2, s[8:11], s36 offen sc1 lds
  s_add_u32 m0, s34, 65536
  s_add_u32 s36, s35, 4194304
  buffer_load_dwordx4 v2, s[8:11], s36 offen sc1 lds
  buffer_load_dwordx4 v[4:7], v2, s[8:11], s31 offen sc1
  buffer_load_dwordx4 v[8:11], v2, s[8:11], s31 offen offset:1024 sc1
  s_add_u32 m0, s34, 32768
  s_add_u32 s36, s35, 2129920
  buffer_load_dwordx4 v2, s[8:11], s36 offen sc1 lds
  s_add_u32 m0, s34, 98304
  s_add_u32 s36, s35, 4227072
  buffer_load_dwordx4 v2, s[8:11], s36 offen sc1 lds
  s_waitcnt vmcnt(6)
  s_nop 1
  v_max_f32_dpp v12, v12, v12 quad_perm:[1,0,3,2] row_mask:0xf bank_mask:0xf
  s_nop 1
  v_max_f32_dpp v12, v12, v12 quad_perm:[2,3,0,1] row_mask:0xf bank_mask:0xf
  s_nop 1
  v_max_f32_dpp v12, v12, v12 row_half_mirror row_mask:0xf bank_mask:0xf
  s_nop 1
  v_max_f32_dpp v12, v12, v12 row_mirror row_mask:0xf bank_mask:0xf
  v_mov_b32 v14, v12
  s_nop 1
  v_permlane16_swap_b32 v12, v14
  s_nop 1
  v_max_f32 v12, v12, v14
  v_mov_b32 v14, v12
  s_nop 1
  v_permlane32_swap_b32 v12, v14
  s_nop 1
  v_max_f32 v12, v12, v14
  s_nop 1
  v_max_f32_dpp v13, v13, v13 quad_perm:[1,0,3,2] row_mask:0xf bank_mask:0xf
  s_nop 1
  v_max_f32_dpp v13, v13, v13 quad_perm:[2,3,0,1] row_mask:0xf bank_mask:0xf
  s_nop 1
  v_max_f32_dpp v13, v13, v13 row_half_mirror row_mask:0xf bank_mask:0xf
  s_nop 1
  v_max_f32_dpp v13, v13, v13 row_mirror row_mask:0xf bank_mask:0xf
  s_nop 1
  v_mul_f32 v12, v12, v13
  s_nop 1
  v_readfirstlane_b32 s42, v12
  s_mov_b32 s43, 0x45610000
  s_nop 3
  s_cmp_le_u32 s42, s43
  s_cbranch_scc0 P2_slow
  s_waitcnt vmcnt(0)
  s_barrier
  ds_read_b128 v[16:19], v137 offset:0
  ds_read_b128 v[20:23], v137 offset:1024
  s_mov_b64 exec, s[40:41]
  ds_read_b128 v[24:27], v138 offset:0
  ds_read_b128 v[28:31], v138 offset:512
  s_mov_b64 exec, -1
  s_waitcnt lgkmcnt(3)
  v_mfma_f32_32x32x16_bf16 v[40:55], v[16:19], v[4:7], 0
  v_mfma_f32_32x32x16_bf16 v[56:71], v[16:19], v[8:11], 0
  s_mov_b64 exec, s[40:41]
  ds_read_b128 v[32:35], v138 offset:1024
  ds_read_b128 v[36:39], v138 offset:1536
  s_mov_b64 exec, -1
  ds_read_b128 v[16:19], v137 offset:2048
  s_nop 7
  v_exp_f32 v40, v40
  v_exp_f32 v41, v41
  v_exp_f32 v42, v42
  v_exp_f32 v43, v43
  v_exp_f32 v44, v44
  v_exp_f32 v45, v45
  v_exp_f32 v46, v46
  v_exp_f32 v47, v47
  v_exp_f32 v48, v48
  v_exp_f32 v49, v49
  v_exp_f32 v50, v50
  v_exp_f32 v51, v51
  s_waitcnt lgkmcnt(3)
  v_smfmac_f32_32x32x32_bf16 v[72:87], v[24:27], v[40:47], v136
  v_exp_f32 v52, v52
  v_exp_f32 v53, v53
  s_add_u32 m0, s34, 8192
  s_add_u32 s36, s35, 2105344
  buffer_load_dwordx4 v2, s[8:11], s36 offen sc1 lds
  v_exp_f32 v54, v54
  v_exp_f32 v55, v55
  v_exp_f32 v56, v56
  v_exp_f32 v57, v57
  v_smfmac_f32_32x32x32_bf16 v[72:87], v[28:31], v[48:55], v136
  v_exp_f32 v58, v58
  v_exp_f32 v59, v59
  v_exp_f32 v60, v60
  v_exp_f32 v61, v61
  s_waitcnt lgkmcnt(0)
  v_exp_f32 v62, v62
  v_mfma_f32_32x32x16_bf16 v[40:55], v[20:23], v[4:7], 0
  v_exp_f32 v63, v63
  v_exp_f32 v64, v64
  v_exp_f32 v65, v65
  v_exp_f32 v66, v66
  v_exp_f32 v67, v67
  v_smfmac_f32_32x32x32_bf16 v[88:103], v[24:27], v[56:63], v136
  v_exp_f32 v68, v68
  v_exp_f32 v69, v69
  s_add_u32 m0, s34, 73728
  s_add_u32 s36, s35, 4202496
  buffer_load_dwordx4 v2, s[8:11], s36 offen sc1 lds
  v_exp_f32 v70, v70
  v_exp_f32 v71, v71
  v_exp_f32 v40, v40
  v_exp_f32 v41, v41
  v_smfmac_f32_32x32x32_bf16 v[88:103], v[28:31], v[64:71], v136
  s_mov_b64 exec, s[40:41]
  ds_read_b128 v[24:27], v138 offset:2048
  ds_read_b128 v[28:31], v138 offset:2560
  s_mov_b64 exec, -1
  v_exp_f32 v42, v42
  v_exp_f32 v43, v43
  v_exp_f32 v44, v44
  v_exp_f32 v45, v45
  v_exp_f32 v46, v46
  v_mfma_f32_32x32x16_bf16 v[56:71], v[20:23], v[8:11], 0
  ds_read_b128 v[20:23], v137 offset:3072
  v_exp_f32 v47, v47
  v_exp_f32 v48, v48
  v_exp_f32 v49, v49
  v_exp_f32 v50, v50
  v_exp_f32 v51, v51
  v_smfmac_f32_32x32x32_bf16 v[72:87], v[32:35], v[40:47], v136
  v_exp_f32 v52, v52
  v_exp_f32 v53, v53
  s_add_u32 m0, s34, 40960
  s_add_u32 s36, s35, 2138112
  buffer_load_dwordx4 v2, s[8:11], s36 offen sc1 lds
  v_exp_f32 v54, v54
  v_exp_f32 v55, v55
  v_exp_f32 v56, v56
  v_exp_f32 v57, v57
  v_smfmac_f32_32x32x32_bf16 v[72:87], v[36:39], v[48:55], v136
  v_exp_f32 v58, v58
  v_exp_f32 v59, v59
  v_exp_f32 v60, v60
  v_exp_f32 v61, v61
  s_waitcnt lgkmcnt(0)
  v_exp_f32 v62, v62
  v_mfma_f32_32x32x16_bf16 v[40:55], v[16:19], v[4:7], 0
  v_exp_f32 v63, v63
  v_exp_f32 v64, v64
  v_exp_f32 v65, v65
  v_exp_f32 v66, v66
  v_exp_f32 v67, v67
  v_smfmac_f32_32x32x32_bf16 v[88:103], v[32:35], v[56:63], v136
  v_exp_f32 v68, v68
  v_exp_f32 v69, v69
  s_add_u32 m0, s34, 106496
  s_add_u32 s36, s35, 4235264
  buffer_load_dwordx4 v2, s[8:11], s36 offen sc1 lds
  v_exp_f32 v70, v70
  v_exp_f32 v71, v71
  v_exp_f32 v40, v40
  v_exp_f32 v41, v41
  v_smfmac_f32_32x32x32_bf16 v[88:103], v[36:39], v[64:71], v136
  s_mov_b64 exec, s[40:41]
  ds_read_b128 v[32:35], v138 offset:3072
  ds_read_b128 v[36:39], v138 offset:3584
  s_mov_b64 exec, -1
  v_exp_f32 v42, v42
  v_exp_f32 v43, v43
  v_exp_f32 v44, v44
  v_exp_f32 v45, v45
  v_exp_f32 v46, v46
  v_mfma_f32_32x32x16_bf16 v[56:71], v[16:19], v[8:11], 0
  ds_read_b128 v[16:19], v137 offset:4096
  v_exp_f32 v47, v47
  v_exp_f32 v48, v48
  v_exp_f32 v49, v49
  v_exp_f32 v50, v50
  v_exp_f32 v51, v51
  v_smfmac_f32_32x32x32_bf16 v[72:87], v[24:27], v[40:47], v136
  v_exp_f32 v52, v52
  v_exp_f32 v53, v53
  s_add_u32 m0, s34, 16384
  s_add_u32 s36, s35, 2113536
  buffer_load_dwordx4 v2, s[8:11], s36 offen sc1 lds
  v_exp_f32 v54, v54
  v_exp_f32 v55, v55
  v_exp_f32 v56, v56
  v_exp_f32 v57, v57
  v_smfmac_f32_32x32x32_bf16 v[72:87], v[28:31], v[48:55], v136
  v_exp_f32 v58, v58
  v_exp_f32 v59, v59
  v_exp_f32 v60, v60
  v_exp_f32 v61, v61
  s_waitcnt lgkmcnt(0)
  v_exp_f32 v62, v62
  v_mfma_f32_32x32x16_bf16 v[40:55], v[20:23], v[4:7], 0
  v_exp_f32 v63, v63
  v_exp_f32 v64, v64
  v_exp_f32 v65, v65
  v_exp_f32 v66, v66
  v_exp_f32 v67, v67
  v_smfmac_f32_32x32x32_bf16 v[88:103], v[24:27], v[56:63], v136
  v_exp_f32 v68, v68
  v_exp_f32 v69, v69
  s_add_u32 m0, s34, 81920
  s_add_u32 s36, s35, 4210688
  buffer_load_dwordx4 v2, s[8:11], s36 offen sc1 lds
  v_exp_f32 v70, v70
  v_exp_f32 v71, v71
  v_exp_f32 v40, v40
  v_exp_f32 v41, v41
  v_smfmac_f32_32x32x32_bf16 v[88:103], v[28:31], v[64:71], v136
  s_mov_b64 exec, s[40:41]
  ds_read_b128 v[24:27], v138 offset:4096
  ds_read_b128 v[28:31], v138 offset:4608
  s_mov_b64 exec, -1
  v_exp_f32 v42, v42
  v_exp_f32 v43, v43
  v_exp_f32 v44, v44
  v_exp_f32 v45, v45
  v_exp_f32 v46, v46
  v_mfma_f32_32x32x16_bf16 v[56:71], v[20:23], v[8:11], 0
  ds_read_b128 v[20:23], v137 offset:5120
  v_exp_f32 v47, v47
  v_exp_f32 v48, v48
  v_exp_f32 v49, v49
  v_exp_f32 v50, v50
  v_exp_f32 v51, v51
  v_smfmac_f32_32x32x32_bf16 v[72:87], v[32:35], v[40:47], v136
  v_exp_f32 v52, v52
  v_exp_f32 v53, v53
  s_add_u32 m0, s34, 49152
  s_add_u32 s36, s35, 2146304
  buffer_load_dwordx4 v2, s[8:11], s36 offen sc1 lds
  v_exp_f32 v54, v54
  v_exp_f32 v55, v55
  v_exp_f32 v56, v56
  v_exp_f32 v57, v57
  v_smfmac_f32_32x32x32_bf16 v[72:87], v[36:39], v[48:55], v136
  v_exp_f32 v58, v58
  v_exp_f32 v59, v59
  v_exp_f32 v60, v60
  v_exp_f32 v61, v61
  s_waitcnt lgkmcnt(0)
  v_exp_f32 v62, v62
  v_mfma_f32_32x32x16_bf16 v[40:55], v[16:19], v[4:7], 0
  v_exp_f32 v63, v63
  v_exp_f32 v64, v64
  v_exp_f32 v65, v65
  v_exp_f32 v66, v66
  v_exp_f32 v67, v67
  v_smfmac_f32_32x32x32_bf16 v[88:103], v[32:35], v[56:63], v136
  v_exp_f32 v68, v68
  v_exp_f32 v69, v69
  s_add_u32 m0, s34, 114688
  s_add_u32 s36, s35, 4243456
  buffer_load_dwordx4 v2, s[8:11], s36 offen sc1 lds
  v_exp_f32 v70, v70
  v_exp_f32 v71, v71
  v_exp_f32 v40, v40
  v_exp_f32 v41, v41
  v_smfmac_f32_32x32x32_bf16 v[88:103], v[36:39], v[64:71], v136
  s_mov_b64 exec, s[40:41]
  ds_read_b128 v[32:35], v138 offset:5120
  ds_read_b128 v[36:39], v138 offset:5632
  s_mov_b64 exec, -1
  v_exp_f32 v42, v42
  v_exp_f32 v43, v43
  v_exp_f32 v44, v44
  v_exp_f32 v45, v45
  v_exp_f32 v46, v46
  v_mfma_f32_32x32x16_bf16 v[56:71], v[16:19], v[8:11], 0
  ds_read_b128 v[16:19], v137 offset:6144
  v_exp_f32 v47, v47
  v_exp_f32 v48, v48
  v_exp_f32 v49, v49
  v_exp_f32 v50, v50
  v_exp_f32 v51, v51
  v_smfmac_f32_32x32x32_bf16 v[72:87], v[24:27], v[40:47], v136
  v_exp_f32 v52, v52
  v_exp_f32 v53, v53
  s_add_u32 m0, s34, 24576
  s_add_u32 s36, s35, 2121728
  buffer_load_dwordx4 v2, s[8:11], s36 offen sc1 lds
  v_exp_f32 v54, v54
  v_exp_f32 v55, v55
  v_exp_f32 v56, v56
  v_exp_f32 v57, v57
  v_smfmac_f32_32x32x32_bf16 v[72:87], v[28:31], v[48:55], v136
  v_exp_f32 v58, v58
  v_exp_f32 v59, v59
  v_exp_f32 v60, v60
  v_exp_f32 v61, v61
  s_waitcnt lgkmcnt(0)
  v_exp_f32 v62, v62
  v_mfma_f32_32x32x16_bf16 v[40:55], v[20:23], v[4:7], 0
  v_exp_f32 v63, v63
  v_exp_f32 v64, v64
  v_exp_f32 v65, v65
  v_exp_f32 v66, v66
  v_exp_f32 v67, v67
  v_smfmac_f32_32x32x32_bf16 v[88:103], v[24:27], v[56:63], v136
  v_exp_f32 v68, v68
  v_exp_f32 v69, v69
  s_add_u32 m0, s34, 90112
  s_add_u32 s36, s35, 4218880
  buffer_load_dwordx4 v2, s[8:11], s36 offen sc1 lds
  v_exp_f32 v70, v70
  v_exp_f32 v71, v71
  v_exp_f32 v40, v40
  v_exp_f32 v41, v41
  v_smfmac_f32_32x32x32_bf16 v[88:103], v[28:31], v[64:71], v136
  s_mov_b64 exec, s[40:41]
  ds_read_b128 v[24:27], v138 offset:6144
  ds_read_b128 v[28:31], v138 offset:6656
  s_mov_b64 exec, -1
  v_exp_f32 v42, v42
  v_exp_f32 v43, v43
  v_exp_f32 v44, v44
  v_exp_f32 v45, v45
  v_exp_f32 v46, v46
  v_mfma_f32_32x32x16_bf16 v[56:71], v[20:23], v[8:11], 0
  ds_read_b128 v[20:23], v137 offset:7168
  v_exp_f32 v47, v47
  v_exp_f32 v48, v48
  v_exp_f32 v49, v49
  v_exp_f32 v50, v50
  v_exp_f32 v51, v51
  v_smfmac_f32_32x32x32_bf16 v[72:87], v[32:35], v[40:47], v136
  v_exp_f32 v52, v52
  v_exp_f32 v53, v53
  s_add_u32 m0, s34, 57344
  s_add_u32 s36, s35, 2154496
  buffer_load_dwordx4 v2, s[8:11], s36 offen sc1 lds
  v_exp_f32 v54, v54
  v_exp_f32 v55, v55
  v_exp_f32 v56, v56
  v_exp_f32 v57, v57
  v_smfmac_f32_32x32x32_bf16 v[72:87], v[36:39], v[48:55], v136
  v_exp_f32 v58, v58
  v_exp_f32 v59, v59
  v_exp_f32 v60, v60
  v_exp_f32 v61, v61
  s_waitcnt lgkmcnt(0)
  v_exp_f32 v62, v62
  v_mfma_f32_32x32x16_bf16 v[40:55], v[16:19], v[4:7], 0
  v_exp_f32 v63, v63
  v_exp_f32 v64, v64
  v_exp_f32 v65, v65
  v_exp_f32 v66, v66
  v_exp_f32 v67, v67
  v_smfmac_f32_32x32x32_bf16 v[88:103], v[32:35], v[56:63], v136
  v_exp_f32 v68, v68
  v_exp_f32 v69, v69
  s_add_u32 m0, s34, 122880
  s_add_u32 s36, s35, 4251648
  buffer_load_dwordx4 v2, s[8:11], s36 offen sc1 lds
  v_exp_f32 v70, v70
  v_exp_f32 v71, v71
  s_waitcnt vmcnt(8)
  s_barrier
  v_exp_f32 v40, v40
  v_exp_f32 v41, v41
  v_smfmac_f32_32x32x32_bf16 v[88:103], v[36:39], v[64:71], v136
  s_mov_b64 exec, s[40:41]
  ds_read_b128 v[32:35], v138 offset:7168
  ds_read_b128 v[36:39], v138 offset:7680
  s_mov_b64 exec, -1
  v_exp_f32 v42, v42
  v_exp_f32 v43, v43
  v_exp_f32 v44, v44
  v_exp_f32 v45, v45
  v_exp_f32 v46, v46
  v_mfma_f32_32x32x16_bf16 v[56:71], v[16:19], v[8:11], 0
  ds_read_b128 v[16:19], v137 offset:8192
  v_exp_f32 v47, v47
  v_exp_f32 v48, v48
  v_exp_f32 v49, v49
  v_exp_f32 v50, v50
  v_exp_f32 v51, v51
  v_smfmac_f32_32x32x32_bf16 v[72:87], v[24:27], v[40:47], v136
  v_exp_f32 v52, v52
  v_exp_f32 v53, v53
  s_lshl_b32 s56, s28, 3
  s_add_u32 s56, s56, s24
  s_lshl_b32 s56, s56, 13
  v_lshlrev_b32 v139, 7, v1
  s_mov_b32 s60, s68
  s_and_b32 s61, s69, 0xffff
  s_mov_b32 s62, 524288
  s_mov_b32 s63, 0x20000
  buffer_load_dword v252, v139, s[60:63], s56 offen
  v_exp_f32 v54, v54
  v_exp_f32 v55, v55
  v_exp_f32 v56, v56
  v_exp_f32 v57, v57
  v_smfmac_f32_32x32x32_bf16 v[72:87], v[28:31], v[48:55], v136
  v_exp_f32 v58, v58
  v_exp_f32 v59, v59
  v_exp_f32 v60, v60
  v_exp_f32 v61, v61
  s_waitcnt lgkmcnt(0)
  v_exp_f32 v62, v62
  v_mfma_f32_32x32x16_bf16 v[40:55], v[20:23], v[4:7], 0
  v_exp_f32 v63, v63
  v_exp_f32 v64, v64
  v_exp_f32 v65, v65
  v_exp_f32 v66, v66
  v_exp_f32 v67, v67
  v_smfmac_f32_32x32x32_bf16 v[88:103], v[24:27], v[56:63], v136
  v_exp_f32 v68, v68
  v_exp_f32 v69, v69
  s_mov_b32 s60, s72
  s_and_b32 s61, s73, 0xffff
  s_mov_b32 s62, 1835008
  s_mov_b32 s63, 0x20000
  buffer_load_dword v252, v139, s[60:63], s56 offen
  v_exp_f32 v70, v70
  v_exp_f32 v71, v71
  v_exp_f32 v40, v40
  v_exp_f32 v41, v41
  v_smfmac_f32_32x32x32_bf16 v[88:103], v[28:31], v[64:71], v136
  s_mov_b64 exec, s[40:41]
  ds_read_b128 v[24:27], v138 offset:8192
  ds_read_b128 v[28:31], v138 offset:8704
  s_mov_b64 exec, -1
  v_exp_f32 v42, v42
  v_exp_f32 v43, v43
  v_exp_f32 v44, v44
  v_exp_f32 v45, v45
  v_exp_f32 v46, v46
  v_mfma_f32_32x32x16_bf16 v[56:71], v[20:23], v[8:11], 0
  ds_read_b128 v[20:23], v137 offset:9216
  v_exp_f32 v47, v47
  v_exp_f32 v48, v48
  v_exp_f32 v49, v49
  v_exp_f32 v50, v50
  v_exp_f32 v51, v51
  v_smfmac_f32_32x32x32_bf16 v[72:87], v[32:35], v[40:47], v136
  v_exp_f32 v52, v52
  v_exp_f32 v53, v53
  v_exp_f32 v54, v54
  v_exp_f32 v55, v55
  v_exp_f32 v56, v56
  v_exp_f32 v57, v57
  v_smfmac_f32_32x32x32_bf16 v[72:87], v[36:39], v[48:55], v136
  v_exp_f32 v58, v58
  v_exp_f32 v59, v59
  v_exp_f32 v60, v60
  v_exp_f32 v61, v61
  s_waitcnt lgkmcnt(0)
  v_exp_f32 v62, v62
  v_mfma_f32_32x32x16_bf16 v[40:55], v[16:19], v[4:7], 0
  v_exp_f32 v63, v63
  v_exp_f32 v64, v64
  v_exp_f32 v65, v65
  v_exp_f32 v66, v66
  v_exp_f32 v67, v67
  v_smfmac_f32_32x32x32_bf16 v[88:103], v[32:35], v[56:63], v136
  v_exp_f32 v68, v68
  v_exp_f32 v69, v69
  s_mov_b32 s60, s76
  s_and_b32 s61, s77, 0xffff
  s_mov_b32 s62, 1835008
  s_mov_b32 s63, 0x20000
  s_lshl_b32 s56, s2, 13
  s_cmp_eq_u32 s24, 0
  s_cselect_b32 s56, s56, 0x7fff0000
  buffer_load_dword v252, v139, s[60:63], s56 offen
  v_exp_f32 v70, v70
  v_exp_f32 v71, v71
  v_add_u32 v137, 8192, v137
  v_add_u32 v138, 8192, v138
  s_mov_b32 s44, 0
  .p2align 6
P2_loop:
  v_exp_f32 v40, v40
  v_exp_f32 v41, v41
  v_smfmac_f32_32x32x32_bf16 v[88:103], v[36:39], v[64:71], v136
  s_mov_b64 exec, s[40:41]
  ds_read_b128 v[32:35], v138 offset:1024
  ds_read_b128 v[36:39], v138 offset:1536
  s_mov_b64 exec, -1
  v_exp_f32 v42, v42
  v_exp_f32 v43, v43
  v_exp_f32 v44, v44
  v_exp_f32 v45, v45
  v_exp_f32 v46, v46
  v_mfma_f32_32x32x16_bf16 v[56:71], v[16:19], v[8:11], 0
  ds_read_b128 v[16:19], v137 offset:2048
  v_exp_f32 v47, v47
  v_exp_f32 v48, v48
  v_exp_f32 v49, v49
  v_exp_f32 v50, v50
  v_exp_f32 v51, v51
  v_smfmac_f32_32x32x32_bf16 v[72:87], v[24:27], v[40:47], v136
  v_exp_f32 v52, v52
  v_exp_f32 v53, v53
  v_exp_f32 v54, v54
  v_exp_f32 v55, v55
  v_exp_f32 v56, v56
  v_exp_f32 v57, v57
  v_smfmac_f32_32x32x32_bf16 v[72:87], v[28:31], v[48:55], v136
  v_exp_f32 v58, v58
  v_exp_f32 v59, v59
  v_exp_f32 v60, v60
  v_exp_f32 v61, v61
  s_waitcnt lgkmcnt(0)
  v_exp_f32 v62, v62
  v_mfma_f32_32x32x16_bf16 v[40:55], v[20:23], v[4:7], 0
  v_exp_f32 v63, v63
  v_exp_f32 v64, v64
  v_exp_f32 v65, v65
  v_exp_f32 v66, v66
  v_exp_f32 v67, v67
  v_smfmac_f32_32x32x32_bf16 v[88:103], v[24:27], v[56:63], v136
  v_exp_f32 v68, v68
  v_exp_f32 v69, v69
  v_exp_f32 v70, v70
  v_exp_f32 v71, v71
  v_exp_f32 v40, v40
  v_exp_f32 v41, v41
  v_smfmac_f32_32x32x32_bf16 v[88:103], v[28:31], v[64:71], v136
  s_mov_b64 exec, s[40:41]
  ds_read_b128 v[24:27], v138 offset:2048
  ds_read_b128 v[28:31], v138 offset:2560
  s_mov_b64 exec, -1
  v_exp_f32 v42, v42
  v_exp_f32 v43, v43
  v_exp_f32 v44, v44
  v_exp_f32 v45, v45
  v_exp_f32 v46, v46
  v_mfma_f32_32x32x16_bf16 v[56:71], v[20:23], v[8:11], 0
  ds_read_b128 v[20:23], v137 offset:3072
  v_exp_f32 v47, v47
  v_exp_f32 v48, v48
  v_exp_f32 v49, v49
  v_exp_f32 v50, v50
  v_exp_f32 v51, v51
  v_smfmac_f32_32x32x32_bf16 v[72:87], v[32:35], v[40:47], v136
  v_exp_f32 v52, v52
  v_exp_f32 v53, v53
  v_exp_f32 v54, v54
  v_exp_f32 v55, v55
  v_exp_f32 v56, v56
  v_exp_f32 v57, v57
  v_smfmac_f32_32x32x32_bf16 v[72:87], v[36:39], v[48:55], v136
  v_exp_f32 v58, v58
  v_exp_f32 v59, v59
  v_exp_f32 v60, v60
  v_exp_f32 v61, v61
  s_waitcnt lgkmcnt(0)
  v_exp_f32 v62, v62
  v_mfma_f32_32x32x16_bf16 v[40:55], v[16:19], v[4:7], 0
  v_exp_f32 v63, v63
  v_exp_f32 v64, v64
  v_exp_f32 v65, v65
  v_exp_f32 v66, v66
  v_exp_f32 v67, v67
  v_smfmac_f32_32x32x32_bf16 v[88:103], v[32:35], v[56:63], v136
  v_exp_f32 v68, v68
  v_exp_f32 v69, v69
  v_exp_f32 v70, v70
  v_exp_f32 v71, v71
  s_cmp_lg_u32 s44, 1
  s_cbranch_scc1 P2_nosync
  s_waitcnt vmcnt(0)
  s_barrier
P2_nosync:
  v_exp_f32 v40, v40
  v_exp_f32 v41, v41
  v_smfmac_f32_32x32x32_bf16 v[88:103], v[36:39], v[64:71], v136
  s_mov_b64 exec, s[40:41]
  ds_read_b128 v[32:35], v138 offset:3072
  ds_read_b128 v[36:39], v138 offset:3584
  s_mov_b64 exec, -1
  v_exp_f32 v42, v42
  v_exp_f32 v43, v43
  v_exp_f32 v44, v44
  v_exp_f32 v45, v45
  v_exp_f32 v46, v46
  v_mfma_f32_32x32x16_bf16 v[56:71], v[16:19], v[8:11], 0
  ds_read_b128 v[16:19], v137 offset:4096
  v_exp_f32 v47, v47
  v_exp_f32 v48, v48
  v_exp_f32 v49, v49
  v_exp_f32 v50, v50
  v_exp_f32 v51, v51
  v_smfmac_f32_32x32x32_bf16 v[72:87], v[24:27], v[40:47], v136
  v_exp_f32 v52, v52
  v_exp_f32 v53, v53
  v_exp_f32 v54, v54
  v_exp_f32 v55, v55
  v_exp_f32 v56, v56
  v_exp_f32 v57, v57
  v_smfmac_f32_32x32x32_bf16 v[72:87], v[28:31], v[48:55], v136
  v_exp_f32 v58, v58
  v_exp_f32 v59, v59
  v_exp_f32 v60, v60
  v_exp_f32 v61, v61
  s_waitcnt lgkmcnt(0)
  v_exp_f32 v62, v62
  v_mfma_f32_32x32x16_bf16 v[40:55], v[20:23], v[4:7], 0
  v_exp_f32 v63, v63
  v_exp_f32 v64, v64
  v_exp_f32 v65, v65
  v_exp_f32 v66, v66
  v_exp_f32 v67, v67
  v_smfmac_f32_32x32x32_bf16 v[88:103], v[24:27], v[56:63], v136
  v_exp_f32 v68, v68
  v_exp_f32 v69, v69
  v_exp_f32 v70, v70
  v_exp_f32 v71, v71
  v_exp_f32 v40, v40
  v_exp_f32 v41, v41
  v_smfmac_f32_32x32x32_bf16 v[88:103], v[28:31], v[64:71], v136
  s_mov_b64 exec, s[40:41]
  ds_read_b128 v[24:27], v138 offset:4096
  ds_read_b128 v[28:31], v138 offset:4608
  s_mov_b64 exec, -1
  v_exp_f32 v42, v42
  v_exp_f32 v43, v43
  v_exp_f32 v44, v44
  v_exp_f32 v45, v45
  v_exp_f32 v46, v46
  v_mfma_f32_32x32x16_bf16 v[56:71], v[20:23], v[8:11], 0
  ds_read_b128 v[20:23], v137 offset:5120
  v_exp_f32 v47, v47
  v_exp_f32 v48, v48
  v_exp_f32 v49, v49
  v_exp_f32 v50, v50
  v_exp_f32 v51, v51
  v_smfmac_f32_32x32x32_bf16 v[72:87], v[32:35], v[40:47], v136
  v_exp_f32 v52, v52
  v_exp_f32 v53, v53
  v_exp_f32 v54, v54
  v_exp_f32 v55, v55
  v_exp_f32 v56, v56
  v_exp_f32 v57, v57
  v_smfmac_f32_32x32x32_bf16 v[72:87], v[36:39], v[48:55], v136
  v_exp_f32 v58, v58
  v_exp_f32 v59, v59
  v_exp_f32 v60, v60
  v_exp_f32 v61, v61
  s_waitcnt lgkmcnt(0)
  v_exp_f32 v62, v62
  v_mfma_f32_32x32x16_bf16 v[40:55], v[16:19], v[4:7], 0
  v_exp_f32 v63, v63
  v_exp_f32 v64, v64
  v_exp_f32 v65, v65
  v_exp_f32 v66, v66
  v_exp_f32 v67, v67
  v_smfmac_f32_32x32x32_bf16 v[88:103], v[32:35], v[56:63], v136
  v_exp_f32 v68, v68
  v_exp_f32 v69, v69
  v_exp_f32 v70, v70
  v_exp_f32 v71, v71
  v_add_u32 v137, 4096, v137
  v_add_u32 v138, 4096, v138
  s_add_u32 s44, s44, 1
  s_cmp_lt_u32 s44, 6
  s_cbranch_scc1 P2_loop
  s_nop 1
  v_smfmac_f32_32x32x32_bf16 v[88:103], v[36:39], v[64:71], v136
P2_xch:
  v_lshlrev_b32 v12, 2, v1
  s_mul_i32 s44, s37, 4608
  s_add_u32 s44, s44, 131072
  v_add_u32 v12, s44, v12
  s_cmp_eq_u32 s38, 0
  s_cbranch_scc1 P2_lo
  s_nop 7
  ds_write_b32 v12, v72 offset:0
  ds_write_b32 v12, v73 offset:256
  ds_write_b32 v12, v74 offset:512
  ds_write_b32 v12, v75 offset:768
  ds_write_b32 v12, v76 offset:1024
  ds_write_b32 v12, v77 offset:1280
  ds_write_b32 v12, v78 offset:1536
  ds_write_b32 v12, v79 offset:1792
  ds_write_b32 v12, v80 offset:2048
  s_waitcnt lgkmcnt(0)
  s_barrier
  ds_read_b32 v40, v12 offset:2304
  ds_read_b32 v41, v12 offset:2560
  ds_read_b32 v42, v12 offset:2816
  ds_read_b32 v43, v12 offset:3072
  ds_read_b32 v44, v12 offset:3328
  ds_read_b32 v45, v12 offset:3584
  ds_read_b32 v46, v12 offset:3840
  ds_read_b32 v47, v12 offset:4096
  ds_read_b32 v48, v12 offset:4352
  s_add_u32 s30, s30, 1
  s_waitcnt lgkmcnt(0)
  v_add_f32 v72, v88, v40
  v_add_f32 v73, v89, v41
  v_add_f32 v74, v90, v42
  v_add_f32 v75, v91, v43
  v_add_f32 v76, v92, v44
  v_add_f32 v77, v93, v45
  v_add_f32 v78, v94, v46
  v_add_f32 v79, v95, v47
  v_add_f32 v80, v96, v48
  s_branch P2_fin
P2_lo:
  s_nop 7
  ds_write_b32 v12, v88 offset:2304
  ds_write_b32 v12, v89 offset:2560
  ds_write_b32 v12, v90 offset:2816
  ds_write_b32 v12, v91 offset:3072
  ds_write_b32 v12, v92 offset:3328
  ds_write_b32 v12, v93 offset:3584
  ds_write_b32 v12, v94 offset:3840
  ds_write_b32 v12, v95 offset:4096
  ds_write_b32 v12, v96 offset:4352
  s_waitcnt lgkmcnt(0)
  s_barrier
  ds_read_b32 v40, v12 offset:0
  ds_read_b32 v41, v12 offset:256
  ds_read_b32 v42, v12 offset:512
  ds_read_b32 v43, v12 offset:768
  ds_read_b32 v44, v12 offset:1024
  ds_read_b32 v45, v12 offset:1280
  ds_read_b32 v46, v12 offset:1536
  ds_read_b32 v47, v12 offset:1792
  ds_read_b32 v48, v12 offset:2048
  s_waitcnt lgkmcnt(0)
  v_add_f32 v72, v72, v40
  v_add_f32 v73, v73, v41
  v_add_f32 v74, v74, v42
  v_add_f32 v75, v75, v43
  v_add_f32 v76, v76, v44
  v_add_f32 v77, v77, v45
  v_add_f32 v78, v78, v46
  v_add_f32 v79, v79, v47
  v_add_f32 v80, v80, v48
P2_fin:
  s_lshl_b32 s45, s30, 5
  s_add_u32 s45, s45, s25
  s_lshl_b32 s45, s45, 10
  v_rcp_f32 v12, v80
  s_nop 0
  v_mul_f32 v72, v72, v12
  v_mul_f32 v73, v73, v12
  v_mul_f32 v74, v74, v12
  v_mul_f32 v75, v75, v12
  v_mul_f32 v76, v76, v12
  v_mul_f32 v77, v77, v12
  v_mul_f32 v78, v78, v12
  v_mul_f32 v79, v79, v12
  v_cvt_pk_bf16_f32 v16, v72, v73
  v_cvt_pk_bf16_f32 v17, v74, v75
  v_cvt_pk_bf16_f32 v18, v76, v77
  v_cvt_pk_bf16_f32 v19, v78, v79
  buffer_store_dwordx4 v[16:19], v2, s[12:15], s45 offen sc1
  s_lshl_b32 s33, s26, 5
  s_add_u32 s33, s33, s25
  s_add_u32 s48, s84, 23068672
  s_addc_u32 s49, s85, 0
  s_and_b32 s49, s49, 0xffff
  s_mov_b32 s50, 135168
  s_mov_b32 s51, 0x20000
  s_add_u32 s46, s33, 256
  s_lshl_b32 s46, s46, 7
  v_mov_b32 v250, 163780
  v_mov_b32 v251, 1
  v_mov_b32 v253, s86
  v_mov_b32 v254, 0
  s_waitcnt vmcnt(0)
  s_mov_b64 exec, 1
  ds_add_rtn_u32 v251, v250, v251
  s_waitcnt lgkmcnt(0)
  v_readfirstlane_b32 s47, v251
  s_nop 3
  s_cmp_lg_u32 s47, 7
  s_cbranch_scc1 P2_arr_L_6
  buffer_store_dword v253, v254, s[48:51], s46 offen sc1
P2_arr_L_6:
  s_mov_b64 exec, -1
  s_and_b32 s27, s2, 7
  s_lshr_b32 s28, s2, 3
  s_lshl_b32 s25, s27, 2
  s_lshr_b32 s29, s28, 3
  s_add_u32 s25, s25, s29
  s_and_b32 s26, s28, 7
  v_lshlrev_b32 v2, 4, v1
  s_add_u32 s8, s84, 8388608
  s_addc_u32 s9, s85, 0
  s_and_b32 s9, s9, 0xffff
  s_mov_b32 s10, 2097152
  s_mov_b32 s11, 0x20000
  s_and_b32 s29, s24, 3
  s_and_b32 s30, s29, 1
  s_lshr_b32 s31, s29, 1
  s_lshl_b32 s32, s25, 1
  s_add_u32 s32, s32, s31
  s_mul_i32 s32, s32, 32
  s_lshl_b32 s33, s30, 1
  s_add_u32 s32, s32, s33
  s_lshl_b32 s32, s32, 10
  s_lshl_b32 s33, s31, 12
  s_lshl_b32 s34, s30, 11
  s_add_u32 s33, s33, s34
  s_mov_b32 s12, s68
  s_and_b32 s13, s69, 0xffff
  s_mov_b32 s14, 524288
  s_mov_b32 s15, 0x20000
  v_lshrrev_b32 v23, 3, v1
  s_mov_b32 s59, 1024
  v_mul_lo_u32 v3, v23, s59
  v_bfe_u32 v23, v1, 4, 1
  v_lshlrev_b32 v23, 2, v23
  v_and_b32 v24, 7, v1
  v_xor_b32 v23, v23, v24
  v_lshl_add_u32 v3, v23, 4, v3
  v_add_u32 v13, 7168, v3
  s_lshl_b32 s34, s29, 14
  s_lshl_b32 s35, s26, 7
  s_add_u32 s34, s34, s35
  s_lshl_b32 s35, s29, 11
  s_cmp_ge_u32 s24, 4
  s_cbranch_scc1 P3_prod
  s_add_u32 s16, s84, 10485760
  s_addc_u32 s17, s85, 0
  s_and_b32 s17, s17, 0xffff
  s_mov_b32 s18, 2097152
  s_mov_b32 s19, 0x20000
  s_mov_b32 s20, s64
  s_and_b32 s21, s65, 0xffff
  s_mov_b32 s22, 2097152
  s_mov_b32 s23, 0x20000
  s_add_u32 s52, s84, 22020096
  s_addc_u32 s53, s85, 0
  s_and_b32 s53, s53, 0xffff
  s_mov_b32 s54, 262144
  s_mov_b32 s55, 0x20000
  v_and_b32 v12, 31, v1
  v_lshrrev_b32 v14, 5, v1
  s_lshl_b32 s38, s25, 1
  s_add_u32 s38, s38, s30
  s_lshl_b32 s39, s26, 1
  s_add_u32 s39, s39, s31
  v_lshlrev_b32 v15, 10, v12
  v_lshl_add_u32 v15, v14, 4, v15
  s_lshl_b32 s40, s38, 15
  s_lshl_b32 s41, s39, 6
  s_add_u32 s40, s40, s41
  s_lshl_b32 s41, s38, 5
  s_lshl_b32 s42, s39, 1
  s_add_u32 s41, s41, s42
  s_lshl_b32 s41, s41, 10
  buffer_load_dwordx4 v[96:99], v15, s[20:23], s40 offen
  buffer_load_dwordx4 v[100:103], v15, s[20:23], s40 offen offset:32
  s_lshl_b32 s37, s30, 12
  v_add_u32 v4, s37, v2
  v_bfe_u32 v20, v1, 2, 2
  v_lshrrev_b32 v21, 5, v1
  v_lshl_add_u32 v21, v21, 3, v20
  v_lshlrev_b32 v8, 7, v21
  v_bfe_u32 v21, v1, 4, 1
  v_and_b32 v22, 1, v1
  v_lshl_add_u32 v21, v21, 1, v22
  s_lshl_b32 s59, s31, 2
  v_add_u32 v21, s59, v21
  v_lshrrev_b32 v20, 1, v20
  v_lshlrev_b32 v20, 2, v20
  v_xor_b32 v21, v21, v20
  v_lshl_add_u32 v8, v21, 4, v8
  v_bfe_u32 v22, v1, 1, 1
  v_lshl_add_u32 v8, v22, 3, v8
  v_add_u32 v5, 65536, v4
  v_add_u32 v9, 65536, v8
  v_add_u32 v6, 131072, v4
  v_add_u32 v10, 131072, v8
  v_mov_b32 v32, 0
  v_mov_b32 v33, 0
  v_mov_b32 v34, 0
  v_mov_b32 v35, 0
  v_mov_b32 v36, 0
  v_mov_b32 v37, 0
  v_mov_b32 v38, 0
  v_mov_b32 v39, 0
  v_mov_b32 v40, 0
  v_mov_b32 v41, 0
  v_mov_b32 v42, 0
  v_mov_b32 v43, 0
  v_mov_b32 v44, 0
  v_mov_b32 v45, 0
  v_mov_b32 v46, 0
  v_mov_b32 v47, 0
  s_cmp_lg_u32 s24, 0
  s_cbranch_scc1 P3np_L_7
  s_lshr_b32 s43, s25, 2
  s_lshl_b32 s43, s43, 5
  s_add_u32 s48, s84, 23068672
  s_addc_u32 s49, s85, 0
  s_and_b32 s49, s49, 0xffff
  s_mov_b32 s50, 135168
  s_mov_b32 s51, 0x20000
  s_add_u32 s46, s43, 256
  s_lshl_b32 s46, s46, 7
  v_lshlrev_b32 v250, 7, v1
  s_mov_b32 s47, 100000
  s_mov_b64 exec, 0xffffffff
  s_waitcnt vmcnt(0)
  buffer_load_dword v251, v250, s[48:51], s46 offen sc1
  s_sleep 4
P3_poll_L_8:
  buffer_load_dword v253, v250, s[48:51], s46 offen sc1
  s_waitcnt vmcnt(1)
  v_cmp_ne_u32 vcc, s86, v251
  s_nop 4
  s_and_b64 exec, exec, vcc
  s_cbranch_execz P3_poll_L_8_ok
  buffer_load_dword v251, v250, s[48:51], s46 offen sc1
  s_waitcnt vmcnt(1)
  v_cmp_ne_u32 vcc, s86, v253
  s_nop 4
  s_and_b64 exec, exec, vcc
  s_cbranch_execz P3_poll_L_8_ok
  s_sub_u32 s47, s47, 1
  s_cmp_eq_u32 s47, 0
  s_cbranch_scc0 P3_poll_L_8
P3_poll_L_8_ok:
  s_mov_b64 exec, -1
P3np_L_7:
  s_barrier
  s_add_u32 m0, s33, 73728
  s_add_u32 s36, s32, 4096
  buffer_load_dwordx4 v2, s[8:11], s36 offen sc1 lds
  buffer_load_dwordx4 v2, s[8:11], s36 offen offset:1024 sc1 lds
  s_add_u32 m0, s33, 90112
  s_add_u32 s36, s32, 12288
  buffer_load_dwordx4 v2, s[8:11], s36 offen sc1 lds
  buffer_load_dwordx4 v2, s[8:11], s36 offen offset:1024 sc1 lds
  s_waitcnt vmcnt(2)
  s_barrier
  ds_read_b128 v[112:115], v5 offset:0
  ds_read_b64_tr_b16 v[116:117], v8 offset:0
  ds_read_b64_tr_b16 v[118:119], v8 offset:512
  ds_read_b128 v[120:123], v5 offset:1024
  ds_read_b64_tr_b16 v[124:125], v8 offset:2048
  ds_read_b64_tr_b16 v[126:127], v8 offset:2560
  ds_read_b128 v[128:131], v5 offset:2048
  ds_read_b64_tr_b16 v[132:133], v8 offset:4096
  ds_read_b64_tr_b16 v[134:135], v8 offset:4608
  ds_read_b128 v[136:139], v5 offset:3072
  ds_read_b64_tr_b16 v[140:141], v8 offset:6144
  ds_read_b64_tr_b16 v[142:143], v8 offset:6656
  ds_read_b128 v[144:147], v5 offset:8192
  ds_read_b64_tr_b16 v[148:149], v8 offset:8192
  ds_read_b64_tr_b16 v[150:151], v8 offset:8704
  ds_read_b128 v[152:155], v5 offset:9216
  ds_read_b64_tr_b16 v[156:157], v8 offset:10240
  ds_read_b64_tr_b16 v[158:159], v8 offset:10752
  ds_read_b128 v[160:163], v5 offset:10240
  ds_read_b64_tr_b16 v[164:165], v8 offset:12288
  ds_read_b64_tr_b16 v[166:167], v8 offset:12800
  ds_read_b128 v[168:171], v5 offset:11264
  ds_read_b64_tr_b16 v[172:173], v8 offset:14336
  ds_read_b64_tr_b16 v[174:175], v8 offset:14848
  s_waitcnt vmcnt(0)
  s_barrier
  s_waitcnt lgkmcnt(0)
  v_mfma_f32_32x32x16_bf16 v[32:47], v[116:119], v[112:115], v[32:47]
  ds_read_b128 v[176:179], v5 offset:16384
  ds_read_b64_tr_b16 v[180:181], v8 offset:16384
  ds_read_b64_tr_b16 v[182:183], v8 offset:16896
  ds_read_b128 v[184:187], v5 offset:17408
  v_mfma_f32_32x32x16_bf16 v[32:47], v[124:127], v[120:123], v[32:47]
  ds_read_b64_tr_b16 v[188:189], v8 offset:18432
  ds_read_b64_tr_b16 v[190:191], v8 offset:18944
  ds_read_b128 v[192:195], v5 offset:18432
  ds_read_b64_tr_b16 v[196:197], v8 offset:20480
  v_mfma_f32_32x32x16_bf16 v[32:47], v[132:135], v[128:131], v[32:47]
  ds_read_b64_tr_b16 v[198:199], v8 offset:20992
  ds_read_b128 v[200:203], v5 offset:19456
  ds_read_b64_tr_b16 v[204:205], v8 offset:22528
  ds_read_b64_tr_b16 v[206:207], v8 offset:23040
  v_mfma_f32_32x32x16_bf16 v[32:47], v[140:143], v[136:139], v[32:47]
  ds_read_b128 v[208:211], v5 offset:24576
  ds_read_b64_tr_b16 v[212:213], v8 offset:24576
  ds_read_b64_tr_b16 v[214:215], v8 offset:25088
  ds_read_b128 v[216:219], v5 offset:25600
  v_mfma_f32_32x32x16_bf16 v[32:47], v[148:151], v[144:147], v[32:47]
  ds_read_b64_tr_b16 v[220:221], v8 offset:26624
  ds_read_b64_tr_b16 v[222:223], v8 offset:27136
  ds_read_b128 v[224:227], v5 offset:26624
  ds_read_b64_tr_b16 v[228:229], v8 offset:28672
  v_mfma_f32_32x32x16_bf16 v[32:47], v[156:159], v[152:155], v[32:47]
  ds_read_b64_tr_b16 v[230:231], v8 offset:29184
  ds_read_b128 v[232:235], v5 offset:27648
  ds_read_b64_tr_b16 v[236:237], v8 offset:30720
  ds_read_b64_tr_b16 v[238:239], v8 offset:31232
  v_mfma_f32_32x32x16_bf16 v[32:47], v[164:167], v[160:163], v[32:47]
  v_mfma_f32_32x32x16_bf16 v[32:47], v[172:175], v[168:171], v[32:47]
  s_barrier
  s_waitcnt lgkmcnt(0)
  v_mfma_f32_32x32x16_bf16 v[32:47], v[180:183], v[176:179], v[32:47]
  ds_read_b128 v[112:115], v5 offset:32768
  ds_read_b64_tr_b16 v[116:117], v8 offset:32768
  ds_read_b64_tr_b16 v[118:119], v8 offset:33280
  ds_read_b128 v[120:123], v5 offset:33792
  v_mfma_f32_32x32x16_bf16 v[32:47], v[188:191], v[184:187], v[32:47]
  ds_read_b64_tr_b16 v[124:125], v8 offset:34816
  ds_read_b64_tr_b16 v[126:127], v8 offset:35328
  ds_read_b128 v[128:131], v5 offset:34816
  ds_read_b64_tr_b16 v[132:133], v8 offset:36864
  v_mfma_f32_32x32x16_bf16 v[32:47], v[196:199], v[192:195], v[32:47]
  ds_read_b64_tr_b16 v[134:135], v8 offset:37376
  ds_read_b128 v[136:139], v5 offset:35840
  ds_read_b64_tr_b16 v[140:141], v8 offset:38912
  ds_read_b64_tr_b16 v[142:143], v8 offset:39424
  v_mfma_f32_32x32x16_bf16 v[32:47], v[204:207], v[200:203], v[32:47]
  ds_read_b128 v[144:147], v5 offset:40960
  ds_read_b64_tr_b16 v[148:149], v8 offset:40960
  ds_read_b64_tr_b16 v[150:151], v8 offset:41472
  ds_read_b128 v[152:155], v5 offset:41984
  v_mfma_f32_32x32x16_bf16 v[32:47], v[212:215], v[208:211], v[32:47]
  ds_read_b64_tr_b16 v[156:157], v8 offset:43008
  ds_read_b64_tr_b16 v[158:159], v8 offset:43520
  ds_read_b128 v[160:163], v5 offset:43008
  ds_read_b64_tr_b16 v[164:165], v8 offset:45056
  v_mfma_f32_32x32x16_bf16 v[32:47], v[220:223], v[216:219], v[32:47]
  ds_read_b64_tr_b16 v[166:167], v8 offset:45568
  ds_read_b128 v[168:171], v5 offset:44032
  ds_read_b64_tr_b16 v[172:173], v8 offset:47104
  ds_read_b64_tr_b16 v[174:175], v8 offset:47616
  v_mfma_f32_32x32x16_bf16 v[32:47], v[228:231], v[224:227], v[32:47]
  v_mfma_f32_32x32x16_bf16 v[32:47], v[236:239], v[232:235], v[32:47]
  s_barrier
  s_waitcnt lgkmcnt(0)
  v_mfma_f32_32x32x16_bf16 v[32:47], v[116:119], v[112:115], v[32:47]
  ds_read_b128 v[176:179], v5 offset:49152
  ds_read_b64_tr_b16 v[180:181], v8 offset:49152
  ds_read_b64_tr_b16 v[182:183], v8 offset:49664
  ds_read_b128 v[184:187], v5 offset:50176
  v_mfma_f32_32x32x16_bf16 v[32:47], v[124:127], v[120:123], v[32:47]
  ds_read_b64_tr_b16 v[188:189], v8 offset:51200
  ds_read_b64_tr_b16 v[190:191], v8 offset:51712
  ds_read_b128 v[192:195], v5 offset:51200
  ds_read_b64_tr_b16 v[196:197], v8 offset:53248
  v_mfma_f32_32x32x16_bf16 v[32:47], v[132:135], v[128:131], v[32:47]
  ds_read_b64_tr_b16 v[198:199], v8 offset:53760
  ds_read_b128 v[200:203], v5 offset:52224
  ds_read_b64_tr_b16 v[204:205], v8 offset:55296
  ds_read_b64_tr_b16 v[206:207], v8 offset:55808
  v_mfma_f32_32x32x16_bf16 v[32:47], v[140:143], v[136:139], v[32:47]
  ds_read_b128 v[208:211], v5 offset:57344
  ds_read_b64_tr_b16 v[212:213], v8 offset:57344
  ds_read_b64_tr_b16 v[214:215], v8 offset:57856
  ds_read_b128 v[216:219], v5 offset:58368
  v_mfma_f32_32x32x16_bf16 v[32:47], v[148:151], v[144:147], v[32:47]
  ds_read_b64_tr_b16 v[220:221], v8 offset:59392
  ds_read_b64_tr_b16 v[222:223], v8 offset:59904
  ds_read_b128 v[224:227], v5 offset:59392
  ds_read_b64_tr_b16 v[228:229], v8 offset:61440
  v_mfma_f32_32x32x16_bf16 v[32:47], v[156:159], v[152:155], v[32:47]
  ds_read_b64_tr_b16 v[230:231], v8 offset:61952
  ds_read_b128 v[232:235], v5 offset:60416
  ds_read_b64_tr_b16 v[236:237], v8 offset:63488
  ds_read_b64_tr_b16 v[238:239], v8 offset:64000
  v_mfma_f32_32x32x16_bf16 v[32:47], v[164:167], v[160:163], v[32:47]
  v_mfma_f32_32x32x16_bf16 v[32:47], v[172:175], v[168:171], v[32:47]
  s_waitcnt lgkmcnt(0)
  s_barrier
  v_mfma_f32_32x32x16_bf16 v[32:47], v[180:183], v[176:179], v[32:47]
  v_mfma_f32_32x32x16_bf16 v[32:47], v[188:191], v[184:187], v[32:47]
  v_mfma_f32_32x32x16_bf16 v[32:47], v[196:199], v[192:195], v[32:47]
  v_mfma_f32_32x32x16_bf16 v[32:47], v[204:207], v[200:203], v[32:47]
  v_mfma_f32_32x32x16_bf16 v[32:47], v[212:215], v[208:211], v[32:47]
  v_mfma_f32_32x32x16_bf16 v[32:47], v[220:223], v[216:219], v[32:47]
  v_mfma_f32_32x32x16_bf16 v[32:47], v[228:231], v[224:227], v[32:47]
  v_mfma_f32_32x32x16_bf16 v[32:47], v[236:239], v[232:235], v[32:47]
  s_waitcnt vmcnt(0)
  v_lshlrev_b32 v64, 16, v96
  v_and_b32 v65, 0xffff0000, v96
  v_lshlrev_b32 v66, 16, v97
  v_and_b32 v67, 0xffff0000, v97
  v_lshlrev_b32 v68, 16, v98
  v_and_b32 v69, 0xffff0000, v98
  v_lshlrev_b32 v70, 16, v99
  v_and_b32 v71, 0xffff0000, v99
  v_lshlrev_b32 v72, 16, v100
  v_and_b32 v73, 0xffff0000, v100
  v_lshlrev_b32 v74, 16, v101
  v_and_b32 v75, 0xffff0000, v101
  v_lshlrev_b32 v76, 16, v102
  v_and_b32 v77, 0xffff0000, v102
  v_lshlrev_b32 v78, 16, v103
  v_and_b32 v79, 0xffff0000, v103
  v_pk_add_f32 v[32:33], v[32:33], v[64:65]
  v_pk_add_f32 v[34:35], v[34:35], v[66:67]
  v_pk_add_f32 v[36:37], v[36:37], v[68:69]
  v_pk_add_f32 v[38:39], v[38:39], v[70:71]
  v_pk_add_f32 v[40:41], v[40:41], v[72:73]
  v_pk_add_f32 v[42:43], v[42:43], v[74:75]
  v_pk_add_f32 v[44:45], v[44:45], v[76:77]
  v_pk_add_f32 v[46:47], v[46:47], v[78:79]
  v_cvt_pk_bf16_f32 v240, v32, v33
  v_cvt_pk_bf16_f32 v241, v34, v35
  v_cvt_pk_bf16_f32 v242, v36, v37
  v_cvt_pk_bf16_f32 v243, v38, v39
  v_cvt_pk_bf16_f32 v244, v40, v41
  v_cvt_pk_bf16_f32 v245, v42, v43
  v_cvt_pk_bf16_f32 v246, v44, v45
  v_cvt_pk_bf16_f32 v247, v46, v47
  buffer_store_dwordx4 v[240:243], v2, s[16:19], s41 offen sc1
  buffer_store_dwordx4 v[244:247], v2, s[16:19], s41 offen offset:1024 sc1
  v_mov_b32 v16, 0
  v_mov_b32 v17, 0
  s_mov_b32 s43, 0x3f803f80
  v_dot2c_f32_bf16 v16, s43, v240
  v_dot2c_f32_bf16 v17, v240, v240
  v_dot2c_f32_bf16 v16, s43, v241
  v_dot2c_f32_bf16 v17, v241, v241
  v_dot2c_f32_bf16 v16, s43, v242
  v_dot2c_f32_bf16 v17, v242, v242
  v_dot2c_f32_bf16 v16, s43, v243
  v_dot2c_f32_bf16 v17, v243, v243
  v_dot2c_f32_bf16 v16, s43, v244
  v_dot2c_f32_bf16 v17, v244, v244
  v_dot2c_f32_bf16 v16, s43, v245
  v_dot2c_f32_bf16 v17, v245, v245
  v_dot2c_f32_bf16 v16, s43, v246
  v_dot2c_f32_bf16 v17, v246, v246
  v_dot2c_f32_bf16 v16, s43, v247
  v_dot2c_f32_bf16 v17, v247, v247
  s_nop 2
  v_mov_b32 v18, v16
  v_mov_b32 v19, v17
  s_nop 1
  v_permlane32_swap_b32 v16, v18
  v_permlane32_swap_b32 v17, v19
  s_nop 1
  v_add_f32 v16, v16, v18
  v_add_f32 v17, v17, v19
  v_lshlrev_b32 v18, 3, v12
  s_lshl_b32 s44, s38, 12
  s_lshl_b32 s45, s39, 8
  s_add_u32 s44, s44, s45
  s_mov_b32 exec_hi, 0
  buffer_store_dwordx2 v[16:17], v18, s[52:55], s44 offen sc1
  s_mov_b64 exec, -1
  s_barrier
  s_lshr_b32 s33, s25, 1
  s_lshl_b32 s33, s33, 4
  s_and_b32 s34, s25, 1
  s_lshl_b32 s34, s34, 3
  s_add_u32 s33, s33, s34
  s_add_u32 s33, s33, s26
  v_lshlrev_b32 v20, 7, v1
  s_add_u32 s48, s84, 23068672
  s_addc_u32 s49, s85, 0
  s_and_b32 s49, s49, 0xffff
  s_mov_b32 s50, 135168
  s_mov_b32 s51, 0x20000
  s_add_u32 s46, s33, 512
  s_lshl_b32 s46, s46, 7
  v_mov_b32 v250, 163784
  v_mov_b32 v251, 1
  v_mov_b32 v253, s86
  v_mov_b32 v254, 0
  s_waitcnt vmcnt(0)
  s_mov_b64 exec, 1
  ds_add_rtn_u32 v251, v250, v251
  s_waitcnt lgkmcnt(0)
  v_readfirstlane_b32 s47, v251
  s_nop 3
  s_cmp_lg_u32 s47, 3
  s_cbranch_scc1 P3_arr_L_9
  buffer_store_dword v253, v254, s[48:51], s46 offen sc1
P3_arr_L_9:
  s_mov_b64 exec, -1
  s_branch P3_join
P3_prod:
  s_add_u32 m0, s35, 0
  s_add_u32 s36, s34, 0
  buffer_load_dwordx4 v3, s[12:15], s36 offen lds
  buffer_load_dwordx4 v13, s[12:15], s36 offen offset:1024 lds
  s_add_u32 m0, s35, 8192
  s_add_u32 s36, s34, 65536
  buffer_load_dwordx4 v3, s[12:15], s36 offen lds
  buffer_load_dwordx4 v13, s[12:15], s36 offen offset:1024 lds
  s_add_u32 m0, s35, 16384
  s_add_u32 s36, s34, 131072
  buffer_load_dwordx4 v3, s[12:15], s36 offen lds
  buffer_load_dwordx4 v13, s[12:15], s36 offen offset:1024 lds
  s_add_u32 m0, s35, 24576
  s_add_u32 s36, s34, 196608
  buffer_load_dwordx4 v3, s[12:15], s36 offen lds
  buffer_load_dwordx4 v13, s[12:15], s36 offen offset:1024 lds
  s_add_u32 m0, s35, 32768
  s_add_u32 s36, s34, 262144
  buffer_load_dwordx4 v3, s[12:15], s36 offen lds
  buffer_load_dwordx4 v13, s[12:15], s36 offen offset:1024 lds
  s_add_u32 m0, s35, 40960
  s_add_u32 s36, s34, 327680
  buffer_load_dwordx4 v3, s[12:15], s36 offen lds
  buffer_load_dwordx4 v13, s[12:15], s36 offen offset:1024 lds
  s_add_u32 m0, s35, 49152
  s_add_u32 s36, s34, 393216
  buffer_load_dwordx4 v3, s[12:15], s36 offen lds
  buffer_load_dwordx4 v13, s[12:15], s36 offen offset:1024 lds
  s_add_u32 m0, s35, 57344
  s_add_u32 s36, s34, 458752
  buffer_load_dwordx4 v3, s[12:15], s36 offen lds
  buffer_load_dwordx4 v13, s[12:15], s36 offen offset:1024 lds
  s_barrier
  s_add_u32 m0, s33, 65536
  s_add_u32 s36, s32, 0
  buffer_load_dwordx4 v2, s[8:11], s36 offen sc1 lds
  buffer_load_dwordx4 v2, s[8:11], s36 offen offset:1024 sc1 lds
  s_add_u32 m0, s33, 81920
  s_add_u32 s36, s32, 8192
  buffer_load_dwordx4 v2, s[8:11], s36 offen sc1 lds
  buffer_load_dwordx4 v2, s[8:11], s36 offen offset:1024 sc1 lds
  s_add_u32 m0, s33, 98304
  s_add_u32 s36, s32, 16384
  buffer_load_dwordx4 v2, s[8:11], s36 offen sc1 lds
  buffer_load_dwordx4 v2, s[8:11], s36 offen offset:1024 sc1 lds
  s_add_u32 m0, s33, 106496
  s_add_u32 s36, s32, 20480
  buffer_load_dwordx4 v2, s[8:11], s36 offen sc1 lds
  buffer_load_dwordx4 v2, s[8:11], s36 offen offset:1024 sc1 lds
  s_add_u32 m0, s33, 114688
  s_add_u32 s36, s32, 24576
  buffer_load_dwordx4 v2, s[8:11], s36 offen sc1 lds
  buffer_load_dwordx4 v2, s[8:11], s36 offen offset:1024 sc1 lds
  s_add_u32 m0, s33, 122880
  s_add_u32 s36, s32, 28672
  buffer_load_dwordx4 v2, s[8:11], s36 offen sc1 lds
  buffer_load_dwordx4 v2, s[8:11], s36 offen offset:1024 sc1 lds
  s_waitcnt vmcnt(10)
  s_barrier
  s_waitcnt vmcnt(8)
  s_barrier
  s_waitcnt vmcnt(4)
  s_barrier
  s_waitcnt vmcnt(0)
  s_barrier
  s_barrier
  s_barrier
P3_join:
  s_and_b32 s27, s2, 7
  s_lshr_b32 s28, s2, 3
  s_cmp_ge_u32 s28, 28
  s_cbranch_scc1 P4_cs
  s_cmp_ge_u32 s28, 14
  s_cselect_b32 s29, 1, 0
  s_lshl_b32 s25, s27, 1
  s_add_u32 s25, s25, s29
  s_mul_i32 s29, s29, 14
  s_sub_u32 s26, s28, s29
  v_lshlrev_b32 v2, 4, v1
  s_cmp_ge_u32 s24, 4
  s_cbranch_scc1 P4_prod
  s_add_u32 s16, s84, 12582912
  s_addc_u32 s17, s85, 0
  s_and_b32 s17, s17, 0xffff
  s_mov_b32 s18, 7340032
  s_mov_b32 s19, 0x20000
  s_mov_b32 s20, s74
  s_and_b32 s21, s75, 0xffff
  s_mov_b32 s22, 3584
  s_mov_b32 s23, 0x20000
  s_and_b32 s30, s24, 1
  s_lshr_b32 s31, s24, 1
  v_and_b32 v12, 31, v1
  v_lshrrev_b32 v14, 5, v1
  s_lshl_b32 s38, s25, 2
  s_lshl_b32 s39, s30, 1
  s_add_u32 s38, s38, s39
  s_lshl_b32 s39, s26, 2
  s_lshl_b32 s40, s31, 1
  s_add_u32 s39, s39, s40
  v_lshlrev_b32 v16, 4, v14
  s_lshl_b32 s40, s39, 6
  buffer_load_dwordx4 v[160:163], v16, s[20:23], s40 offen offset:0
  buffer_load_dwordx4 v[164:167], v16, s[20:23], s40 offen offset:32
  buffer_load_dwordx4 v[168:171], v16, s[20:23], s40 offen offset:64
  buffer_load_dwordx4 v[172:175], v16, s[20:23], s40 offen offset:96
  s_lshl_b32 s37, s30, 12
  v_add_u32 v3, s37, v2
  v_bfe_u32 v20, v1, 2, 2
  v_lshrrev_b32 v21, 5, v1
  v_lshl_add_u32 v21, v21, 3, v20
  v_lshlrev_b32 v6, 7, v21
  v_bfe_u32 v21, v1, 4, 1
  v_and_b32 v22, 1, v1
  v_lshl_add_u32 v21, v21, 1, v22
  v_lshrrev_b32 v20, 1, v20
  v_lshlrev_b32 v20, 2, v20
  v_xor_b32 v21, v21, v20
  v_lshl_add_u32 v6, v21, 4, v6
  v_bfe_u32 v22, v1, 1, 1
  v_lshl_add_u32 v6, v22, 3, v6
  v_xor_b32 v9, 64, v6
  s_lshl_b32 s37, s31, 12
  v_add_u32 v6, s37, v6
  v_add_u32 v9, s37, v9
  v_add_u32 v4, 0x10000, v3
  v_add_u32 v5, 0x20000, v3
  v_add_u32 v7, 0x10000, v6
  v_add_u32 v8, 0x20000, v6
  v_add_u32 v10, 0x10000, v9
  v_add_u32 v11, 0x20000, v9
  v_mov_b32 v32, 0
  v_mov_b32 v33, 0
  v_mov_b32 v34, 0
  v_mov_b32 v35, 0
  v_mov_b32 v36, 0
  v_mov_b32 v37, 0
  v_mov_b32 v38, 0
  v_mov_b32 v39, 0
  v_mov_b32 v40, 0
  v_mov_b32 v41, 0
  v_mov_b32 v42, 0
  v_mov_b32 v43, 0
  v_mov_b32 v44, 0
  v_mov_b32 v45, 0
  v_mov_b32 v46, 0
  v_mov_b32 v47, 0
  v_mov_b32 v48, 0
  v_mov_b32 v49, 0
  v_mov_b32 v50, 0
  v_mov_b32 v51, 0
  v_mov_b32 v52, 0
  v_mov_b32 v53, 0
  v_mov_b32 v54, 0
  v_mov_b32 v55, 0
  v_mov_b32 v56, 0
  v_mov_b32 v57, 0
  v_mov_b32 v58, 0
  v_mov_b32 v59, 0
  v_mov_b32 v60, 0
  v_mov_b32 v61, 0
  v_mov_b32 v62, 0
  v_mov_b32 v63, 0
  v_mov_b32 v64, 0
  v_mov_b32 v65, 0
  v_mov_b32 v66, 0
  v_mov_b32 v67, 0
  v_mov_b32 v68, 0
  v_mov_b32 v69, 0
  v_mov_b32 v70, 0
  v_mov_b32 v71, 0
  v_mov_b32 v72, 0
  v_mov_b32 v73, 0
  v_mov_b32 v74, 0
  v_mov_b32 v75, 0
  v_mov_b32 v76, 0
  v_mov_b32 v77, 0
  v_mov_b32 v78, 0
  v_mov_b32 v79, 0
  v_mov_b32 v80, 0
  v_mov_b32 v81, 0
  v_mov_b32 v82, 0
  v_mov_b32 v83, 0
  v_mov_b32 v84, 0
  v_mov_b32 v85, 0
  v_mov_b32 v86, 0
  v_mov_b32 v87, 0
  v_mov_b32 v88, 0
  v_mov_b32 v89, 0
  v_mov_b32 v90, 0
  v_mov_b32 v91, 0
  v_mov_b32 v92, 0
  v_mov_b32 v93, 0
  v_mov_b32 v94, 0
  v_mov_b32 v95, 0
  s_cmp_lg_u32 s24, 0
  s_cbranch_scc1 P4np_L_10
  s_lshl_b32 s43, s25, 4
  s_add_u32 s48, s84, 23068672
  s_addc_u32 s49, s85, 0
  s_and_b32 s49, s49, 0xffff
  s_mov_b32 s50, 135168
  s_mov_b32 s51, 0x20000
  s_add_u32 s46, s43, 512
  s_lshl_b32 s46, s46, 7
  v_lshlrev_b32 v250, 7, v1
  s_mov_b32 s47, 100000
  s_mov_b64 exec, 0xffff
  s_waitcnt vmcnt(0)
  buffer_load_dword v251, v250, s[48:51], s46 offen sc1
  s_sleep 4
P4_poll_L_11:
  buffer_load_dword v253, v250, s[48:51], s46 offen sc1
  s_waitcnt vmcnt(1)
  v_cmp_ne_u32 vcc, s86, v251
  s_nop 4
  s_and_b64 exec, exec, vcc
  s_cbranch_execz P4_poll_L_11_ok
  buffer_load_dword v251, v250, s[48:51], s46 offen sc1
  s_waitcnt vmcnt(1)
  v_cmp_ne_u32 vcc, s86, v253
  s_nop 4
  s_and_b64 exec, exec, vcc
  s_cbranch_execz P4_poll_L_11_ok
  s_sub_u32 s47, s47, 1
  s_cmp_eq_u32 s47, 0
  s_cbranch_scc0 P4_poll_L_11
P4_poll_L_11_ok:
  s_mov_b64 exec, -1
P4np_L_10:
  s_barrier
  s_barrier
  ds_read_b128 v[96:99], v4 offset:16384
  ds_read_b64_tr_b16 v[104:105], v6 offset:0
  ds_read_b64_tr_b16 v[106:107], v6 offset:512
  ds_read_b128 v[100:103], v4 offset:18432
  ds_read_b64_tr_b16 v[108:109], v9 offset:0
  ds_read_b64_tr_b16 v[110:111], v9 offset:512
  ds_read_b128 v[112:115], v4 offset:17408
  ds_read_b64_tr_b16 v[120:121], v6 offset:2048
  ds_read_b64_tr_b16 v[122:123], v6 offset:2560
  ds_read_b128 v[116:119], v4 offset:19456
  ds_read_b64_tr_b16 v[124:125], v9 offset:2048
  ds_read_b64_tr_b16 v[126:127], v9 offset:2560
  s_barrier
  s_waitcnt lgkmcnt(0)
  v_mfma_f32_32x32x16_bf16 v[32:47], v[104:107], v[96:99], v[32:47]
  ds_read_b128 v[128:131], v4 offset:24576
  ds_read_b64_tr_b16 v[136:137], v6 offset:8192
  ds_read_b64_tr_b16 v[138:139], v6 offset:8704
  v_mfma_f32_32x32x16_bf16 v[48:63], v[108:111], v[96:99], v[48:63]
  ds_read_b128 v[132:135], v4 offset:26624
  ds_read_b64_tr_b16 v[140:141], v9 offset:8192
  ds_read_b64_tr_b16 v[142:143], v9 offset:8704
  v_mfma_f32_32x32x16_bf16 v[64:79], v[104:107], v[100:103], v[64:79]
  ds_read_b128 v[144:147], v4 offset:25600
  ds_read_b64_tr_b16 v[152:153], v6 offset:10240
  ds_read_b64_tr_b16 v[154:155], v6 offset:10752
  v_mfma_f32_32x32x16_bf16 v[80:95], v[108:111], v[100:103], v[80:95]
  ds_read_b128 v[148:151], v4 offset:27648
  ds_read_b64_tr_b16 v[156:157], v9 offset:10240
  ds_read_b64_tr_b16 v[158:159], v9 offset:10752
  v_mfma_f32_32x32x16_bf16 v[32:47], v[120:123], v[112:115], v[32:47]
  v_mfma_f32_32x32x16_bf16 v[48:63], v[124:127], v[112:115], v[48:63]
  v_mfma_f32_32x32x16_bf16 v[64:79], v[120:123], v[116:119], v[64:79]
  v_mfma_f32_32x32x16_bf16 v[80:95], v[124:127], v[116:119], v[80:95]
  s_barrier
  s_waitcnt lgkmcnt(0)
  v_mfma_f32_32x32x16_bf16 v[32:47], v[136:139], v[128:131], v[32:47]
  ds_read_b128 v[96:99], v4 offset:32768
  ds_read_b64_tr_b16 v[104:105], v6 offset:16384
  ds_read_b64_tr_b16 v[106:107], v6 offset:16896
  v_mfma_f32_32x32x16_bf16 v[48:63], v[140:143], v[128:131], v[48:63]
  ds_read_b128 v[100:103], v4 offset:34816
  ds_read_b64_tr_b16 v[108:109], v9 offset:16384
  ds_read_b64_tr_b16 v[110:111], v9 offset:16896
  v_mfma_f32_32x32x16_bf16 v[64:79], v[136:139], v[132:135], v[64:79]
  ds_read_b128 v[112:115], v4 offset:33792
  ds_read_b64_tr_b16 v[120:121], v6 offset:18432
  ds_read_b64_tr_b16 v[122:123], v6 offset:18944
  v_mfma_f32_32x32x16_bf16 v[80:95], v[140:143], v[132:135], v[80:95]
  ds_read_b128 v[116:119], v4 offset:35840
  ds_read_b64_tr_b16 v[124:125], v9 offset:18432
  ds_read_b64_tr_b16 v[126:127], v9 offset:18944
  v_mfma_f32_32x32x16_bf16 v[32:47], v[152:155], v[144:147], v[32:47]
  v_mfma_f32_32x32x16_bf16 v[48:63], v[156:159], v[144:147], v[48:63]
  v_mfma_f32_32x32x16_bf16 v[64:79], v[152:155], v[148:151], v[64:79]
  v_mfma_f32_32x32x16_bf16 v[80:95], v[156:159], v[148:151], v[80:95]
  s_barrier
  s_waitcnt lgkmcnt(0)
  v_mfma_f32_32x32x16_bf16 v[32:47], v[104:107], v[96:99], v[32:47]
  ds_read_b128 v[128:131], v4 offset:40960
  ds_read_b64_tr_b16 v[136:137], v6 offset:24576
  ds_read_b64_tr_b16 v[138:139], v6 offset:25088
  v_mfma_f32_32x32x16_bf16 v[48:63], v[108:111], v[96:99], v[48:63]
  ds_read_b128 v[132:135], v4 offset:43008
  ds_read_b64_tr_b16 v[140:141], v9 offset:24576
  ds_read_b64_tr_b16 v[142:143], v9 offset:25088
  v_mfma_f32_32x32x16_bf16 v[64:79], v[104:107], v[100:103], v[64:79]
  ds_read_b128 v[144:147], v4 offset:41984
  ds_read_b64_tr_b16 v[152:153], v6 offset:26624
  ds_read_b64_tr_b16 v[154:155], v6 offset:27136
  v_mfma_f32_32x32x16_bf16 v[80:95], v[108:111], v[100:103], v[80:95]
  ds_read_b128 v[148:151], v4 offset:44032
  ds_read_b64_tr_b16 v[156:157], v9 offset:26624
  ds_read_b64_tr_b16 v[158:159], v9 offset:27136
  v_mfma_f32_32x32x16_bf16 v[32:47], v[120:123], v[112:115], v[32:47]
  v_mfma_f32_32x32x16_bf16 v[48:63], v[124:127], v[112:115], v[48:63]
  v_mfma_f32_32x32x16_bf16 v[64:79], v[120:123], v[116:119], v[64:79]
  v_mfma_f32_32x32x16_bf16 v[80:95], v[124:127], v[116:119], v[80:95]
  s_barrier
  s_waitcnt lgkmcnt(0)
  v_mfma_f32_32x32x16_bf16 v[32:47], v[136:139], v[128:131], v[32:47]
  ds_read_b128 v[96:99], v4 offset:49152
  ds_read_b64_tr_b16 v[104:105], v6 offset:32768
  ds_read_b64_tr_b16 v[106:107], v6 offset:33280
  v_mfma_f32_32x32x16_bf16 v[48:63], v[140:143], v[128:131], v[48:63]
  ds_read_b128 v[100:103], v4 offset:51200
  ds_read_b64_tr_b16 v[108:109], v9 offset:32768
  ds_read_b64_tr_b16 v[110:111], v9 offset:33280
  v_mfma_f32_32x32x16_bf16 v[64:79], v[136:139], v[132:135], v[64:79]
  ds_read_b128 v[112:115], v4 offset:50176
  ds_read_b64_tr_b16 v[120:121], v6 offset:34816
  ds_read_b64_tr_b16 v[122:123], v6 offset:35328
  v_mfma_f32_32x32x16_bf16 v[80:95], v[140:143], v[132:135], v[80:95]
  ds_read_b128 v[116:119], v4 offset:52224
  ds_read_b64_tr_b16 v[124:125], v9 offset:34816
  ds_read_b64_tr_b16 v[126:127], v9 offset:35328
  v_mfma_f32_32x32x16_bf16 v[32:47], v[152:155], v[144:147], v[32:47]
  v_mfma_f32_32x32x16_bf16 v[48:63], v[156:159], v[144:147], v[48:63]
  v_mfma_f32_32x32x16_bf16 v[64:79], v[152:155], v[148:151], v[64:79]
  v_mfma_f32_32x32x16_bf16 v[80:95], v[156:159], v[148:151], v[80:95]
  s_barrier
  s_waitcnt lgkmcnt(0)
  v_mfma_f32_32x32x16_bf16 v[32:47], v[104:107], v[96:99], v[32:47]
  ds_read_b128 v[128:131], v4 offset:57344
  ds_read_b64_tr_b16 v[136:137], v6 offset:40960
  ds_read_b64_tr_b16 v[138:139], v6 offset:41472
  v_mfma_f32_32x32x16_bf16 v[48:63], v[108:111], v[96:99], v[48:63]
  ds_read_b128 v[132:135], v4 offset:59392
  ds_read_b64_tr_b16 v[140:141], v9 offset:40960
  ds_read_b64_tr_b16 v[142:143], v9 offset:41472
  v_mfma_f32_32x32x16_bf16 v[64:79], v[104:107], v[100:103], v[64:79]
  ds_read_b128 v[144:147], v4 offset:58368
  ds_read_b64_tr_b16 v[152:153], v6 offset:43008
  ds_read_b64_tr_b16 v[154:155], v6 offset:43520
  v_mfma_f32_32x32x16_bf16 v[80:95], v[108:111], v[100:103], v[80:95]
  ds_read_b128 v[148:151], v4 offset:60416
  ds_read_b64_tr_b16 v[156:157], v9 offset:43008
  ds_read_b64_tr_b16 v[158:159], v9 offset:43520
  v_mfma_f32_32x32x16_bf16 v[32:47], v[120:123], v[112:115], v[32:47]
  v_mfma_f32_32x32x16_bf16 v[48:63], v[124:127], v[112:115], v[48:63]
  v_mfma_f32_32x32x16_bf16 v[64:79], v[120:123], v[116:119], v[64:79]
  v_mfma_f32_32x32x16_bf16 v[80:95], v[124:127], v[116:119], v[80:95]
  s_barrier
  s_waitcnt lgkmcnt(0)
  v_mfma_f32_32x32x16_bf16 v[32:47], v[136:139], v[128:131], v[32:47]
  ds_read_b128 v[96:99], v5 offset:0
  ds_read_b64_tr_b16 v[104:105], v6 offset:49152
  ds_read_b64_tr_b16 v[106:107], v6 offset:49664
  v_mfma_f32_32x32x16_bf16 v[48:63], v[140:143], v[128:131], v[48:63]
  ds_read_b128 v[100:103], v5 offset:2048
  ds_read_b64_tr_b16 v[108:109], v9 offset:49152
  ds_read_b64_tr_b16 v[110:111], v9 offset:49664
  v_mfma_f32_32x32x16_bf16 v[64:79], v[136:139], v[132:135], v[64:79]
  ds_read_b128 v[112:115], v5 offset:1024
  ds_read_b64_tr_b16 v[120:121], v6 offset:51200
  ds_read_b64_tr_b16 v[122:123], v6 offset:51712
  v_mfma_f32_32x32x16_bf16 v[80:95], v[140:143], v[132:135], v[80:95]
  ds_read_b128 v[116:119], v5 offset:3072
  ds_read_b64_tr_b16 v[124:125], v9 offset:51200
  ds_read_b64_tr_b16 v[126:127], v9 offset:51712
  v_mfma_f32_32x32x16_bf16 v[32:47], v[152:155], v[144:147], v[32:47]
  v_mfma_f32_32x32x16_bf16 v[48:63], v[156:159], v[144:147], v[48:63]
  v_mfma_f32_32x32x16_bf16 v[64:79], v[152:155], v[148:151], v[64:79]
  v_mfma_f32_32x32x16_bf16 v[80:95], v[156:159], v[148:151], v[80:95]
  s_barrier
  s_waitcnt lgkmcnt(0)
  v_mfma_f32_32x32x16_bf16 v[32:47], v[104:107], v[96:99], v[32:47]
  ds_read_b128 v[128:131], v5 offset:8192
  ds_read_b64_tr_b16 v[136:137], v6 offset:57344
  ds_read_b64_tr_b16 v[138:139], v6 offset:57856
  v_mfma_f32_32x32x16_bf16 v[48:63], v[108:111], v[96:99], v[48:63]
  ds_read_b128 v[132:135], v5 offset:10240
  ds_read_b64_tr_b16 v[140:141], v9 offset:57344
  ds_read_b64_tr_b16 v[142:143], v9 offset:57856
  v_mfma_f32_32x32x16_bf16 v[64:79], v[104:107], v[100:103], v[64:79]
  ds_read_b128 v[144:147], v5 offset:9216
  ds_read_b64_tr_b16 v[152:153], v6 offset:59392
  ds_read_b64_tr_b16 v[154:155], v6 offset:59904
  v_mfma_f32_32x32x16_bf16 v[80:95], v[108:111], v[100:103], v[80:95]
  ds_read_b128 v[148:151], v5 offset:11264
  ds_read_b64_tr_b16 v[156:157], v9 offset:59392
  ds_read_b64_tr_b16 v[158:159], v9 offset:59904
  v_mfma_f32_32x32x16_bf16 v[32:47], v[120:123], v[112:115], v[32:47]
  v_mfma_f32_32x32x16_bf16 v[48:63], v[124:127], v[112:115], v[48:63]
  v_mfma_f32_32x32x16_bf16 v[64:79], v[120:123], v[116:119], v[64:79]
  v_mfma_f32_32x32x16_bf16 v[80:95], v[124:127], v[116:119], v[80:95]
  s_barrier
  s_waitcnt lgkmcnt(0)
  v_mfma_f32_32x32x16_bf16 v[32:47], v[136:139], v[128:131], v[32:47]
  ds_read_b128 v[96:99], v5 offset:16384
  ds_read_b64_tr_b16 v[104:105], v7 offset:0
  ds_read_b64_tr_b16 v[106:107], v7 offset:512
  v_mfma_f32_32x32x16_bf16 v[48:63], v[140:143], v[128:131], v[48:63]
  ds_read_b128 v[100:103], v5 offset:18432
  ds_read_b64_tr_b16 v[108:109], v10 offset:0
  ds_read_b64_tr_b16 v[110:111], v10 offset:512
  v_mfma_f32_32x32x16_bf16 v[64:79], v[136:139], v[132:135], v[64:79]
  ds_read_b128 v[112:115], v5 offset:17408
  ds_read_b64_tr_b16 v[120:121], v7 offset:2048
  ds_read_b64_tr_b16 v[122:123], v7 offset:2560
  v_mfma_f32_32x32x16_bf16 v[80:95], v[140:143], v[132:135], v[80:95]
  ds_read_b128 v[116:119], v5 offset:19456
  ds_read_b64_tr_b16 v[124:125], v10 offset:2048
  ds_read_b64_tr_b16 v[126:127], v10 offset:2560
  v_mfma_f32_32x32x16_bf16 v[32:47], v[152:155], v[144:147], v[32:47]
  v_mfma_f32_32x32x16_bf16 v[48:63], v[156:159], v[144:147], v[48:63]
  v_mfma_f32_32x32x16_bf16 v[64:79], v[152:155], v[148:151], v[64:79]
  v_mfma_f32_32x32x16_bf16 v[80:95], v[156:159], v[148:151], v[80:95]
  s_barrier
  s_waitcnt lgkmcnt(0)
  v_mfma_f32_32x32x16_bf16 v[32:47], v[104:107], v[96:99], v[32:47]
  ds_read_b128 v[128:131], v4 offset:16384
  ds_read_b64_tr_b16 v[136:137], v7 offset:8192
  ds_read_b64_tr_b16 v[138:139], v7 offset:8704
  v_mfma_f32_32x32x16_bf16 v[48:63], v[108:111], v[96:99], v[48:63]
  ds_read_b128 v[132:135], v4 offset:18432
  ds_read_b64_tr_b16 v[140:141], v10 offset:8192
  ds_read_b64_tr_b16 v[142:143], v10 offset:8704
  v_mfma_f32_32x32x16_bf16 v[64:79], v[104:107], v[100:103], v[64:79]
  ds_read_b128 v[144:147], v4 offset:17408
  ds_read_b64_tr_b16 v[152:153], v7 offset:10240
  ds_read_b64_tr_b16 v[154:155], v7 offset:10752
  v_mfma_f32_32x32x16_bf16 v[80:95], v[108:111], v[100:103], v[80:95]
  ds_read_b128 v[148:151], v4 offset:19456
  ds_read_b64_tr_b16 v[156:157], v10 offset:10240
  ds_read_b64_tr_b16 v[158:159], v10 offset:10752
  v_mfma_f32_32x32x16_bf16 v[32:47], v[120:123], v[112:115], v[32:47]
  v_mfma_f32_32x32x16_bf16 v[48:63], v[124:127], v[112:115], v[48:63]
  v_mfma_f32_32x32x16_bf16 v[64:79], v[120:123], v[116:119], v[64:79]
  v_mfma_f32_32x32x16_bf16 v[80:95], v[124:127], v[116:119], v[80:95]
  s_barrier
  s_waitcnt lgkmcnt(0)
  v_mfma_f32_32x32x16_bf16 v[32:47], v[136:139], v[128:131], v[32:47]
  ds_read_b128 v[96:99], v4 offset:24576
  ds_read_b64_tr_b16 v[104:105], v6 offset:0
  ds_read_b64_tr_b16 v[106:107], v6 offset:512
  v_mfma_f32_32x32x16_bf16 v[48:63], v[140:143], v[128:131], v[48:63]
  ds_read_b128 v[100:103], v4 offset:26624
  ds_read_b64_tr_b16 v[108:109], v9 offset:0
  ds_read_b64_tr_b16 v[110:111], v9 offset:512
  v_mfma_f32_32x32x16_bf16 v[64:79], v[136:139], v[132:135], v[64:79]
  ds_read_b128 v[112:115], v4 offset:25600
  ds_read_b64_tr_b16 v[120:121], v6 offset:2048
  ds_read_b64_tr_b16 v[122:123], v6 offset:2560
  v_mfma_f32_32x32x16_bf16 v[80:95], v[140:143], v[132:135], v[80:95]
  ds_read_b128 v[116:119], v4 offset:27648
  ds_read_b64_tr_b16 v[124:125], v9 offset:2048
  ds_read_b64_tr_b16 v[126:127], v9 offset:2560
  v_mfma_f32_32x32x16_bf16 v[32:47], v[152:155], v[144:147], v[32:47]
  v_mfma_f32_32x32x16_bf16 v[48:63], v[156:159], v[144:147], v[48:63]
  v_mfma_f32_32x32x16_bf16 v[64:79], v[152:155], v[148:151], v[64:79]
  v_mfma_f32_32x32x16_bf16 v[80:95], v[156:159], v[148:151], v[80:95]
  s_barrier
  s_waitcnt lgkmcnt(0)
  v_mfma_f32_32x32x16_bf16 v[32:47], v[104:107], v[96:99], v[32:47]
  ds_read_b128 v[128:131], v4 offset:32768
  ds_read_b64_tr_b16 v[136:137], v6 offset:8192
  ds_read_b64_tr_b16 v[138:139], v6 offset:8704
  v_mfma_f32_32x32x16_bf16 v[48:63], v[108:111], v[96:99], v[48:63]
  ds_read_b128 v[132:135], v4 offset:34816
  ds_read_b64_tr_b16 v[140:141], v9 offset:8192
  ds_read_b64_tr_b16 v[142:143], v9 offset:8704
  v_mfma_f32_32x32x16_bf16 v[64:79], v[104:107], v[100:103], v[64:79]
  ds_read_b128 v[144:147], v4 offset:33792
  ds_read_b64_tr_b16 v[152:153], v6 offset:10240
  ds_read_b64_tr_b16 v[154:155], v6 offset:10752
  v_mfma_f32_32x32x16_bf16 v[80:95], v[108:111], v[100:103], v[80:95]
  ds_read_b128 v[148:151], v4 offset:35840
  ds_read_b64_tr_b16 v[156:157], v9 offset:10240
  ds_read_b64_tr_b16 v[158:159], v9 offset:10752
  v_mfma_f32_32x32x16_bf16 v[32:47], v[120:123], v[112:115], v[32:47]
  v_mfma_f32_32x32x16_bf16 v[48:63], v[124:127], v[112:115], v[48:63]
  v_mfma_f32_32x32x16_bf16 v[64:79], v[120:123], v[116:119], v[64:79]
  v_mfma_f32_32x32x16_bf16 v[80:95], v[124:127], v[116:119], v[80:95]
  s_barrier
  s_waitcnt lgkmcnt(0)
  v_mfma_f32_32x32x16_bf16 v[32:47], v[136:139], v[128:131], v[32:47]
  ds_read_b128 v[96:99], v4 offset:40960
  ds_read_b64_tr_b16 v[104:105], v6 offset:16384
  ds_read_b64_tr_b16 v[106:107], v6 offset:16896
  v_mfma_f32_32x32x16_bf16 v[48:63], v[140:143], v[128:131], v[48:63]
  ds_read_b128 v[100:103], v4 offset:43008
  ds_read_b64_tr_b16 v[108:109], v9 offset:16384
  ds_read_b64_tr_b16 v[110:111], v9 offset:16896
  v_mfma_f32_32x32x16_bf16 v[64:79], v[136:139], v[132:135], v[64:79]
  ds_read_b128 v[112:115], v4 offset:41984
  ds_read_b64_tr_b16 v[120:121], v6 offset:18432
  ds_read_b64_tr_b16 v[122:123], v6 offset:18944
  v_mfma_f32_32x32x16_bf16 v[80:95], v[140:143], v[132:135], v[80:95]
  ds_read_b128 v[116:119], v4 offset:44032
  ds_read_b64_tr_b16 v[124:125], v9 offset:18432
  ds_read_b64_tr_b16 v[126:127], v9 offset:18944
  v_mfma_f32_32x32x16_bf16 v[32:47], v[152:155], v[144:147], v[32:47]
  v_mfma_f32_32x32x16_bf16 v[48:63], v[156:159], v[144:147], v[48:63]
  v_mfma_f32_32x32x16_bf16 v[64:79], v[152:155], v[148:151], v[64:79]
  v_mfma_f32_32x32x16_bf16 v[80:95], v[156:159], v[148:151], v[80:95]
  s_barrier
  s_waitcnt lgkmcnt(0)
  v_mfma_f32_32x32x16_bf16 v[32:47], v[104:107], v[96:99], v[32:47]
  ds_read_b128 v[128:131], v4 offset:49152
  ds_read_b64_tr_b16 v[136:137], v6 offset:24576
  ds_read_b64_tr_b16 v[138:139], v6 offset:25088
  v_mfma_f32_32x32x16_bf16 v[48:63], v[108:111], v[96:99], v[48:63]
  ds_read_b128 v[132:135], v4 offset:51200
  ds_read_b64_tr_b16 v[140:141], v9 offset:24576
  ds_read_b64_tr_b16 v[142:143], v9 offset:25088
  v_mfma_f32_32x32x16_bf16 v[64:79], v[104:107], v[100:103], v[64:79]
  ds_read_b128 v[144:147], v4 offset:50176
  ds_read_b64_tr_b16 v[152:153], v6 offset:26624
  ds_read_b64_tr_b16 v[154:155], v6 offset:27136
  v_mfma_f32_32x32x16_bf16 v[80:95], v[108:111], v[100:103], v[80:95]
  ds_read_b128 v[148:151], v4 offset:52224
  ds_read_b64_tr_b16 v[156:157], v9 offset:26624
  ds_read_b64_tr_b16 v[158:159], v9 offset:27136
  v_mfma_f32_32x32x16_bf16 v[32:47], v[120:123], v[112:115], v[32:47]
  v_mfma_f32_32x32x16_bf16 v[48:63], v[124:127], v[112:115], v[48:63]
  v_mfma_f32_32x32x16_bf16 v[64:79], v[120:123], v[116:119], v[64:79]
  v_mfma_f32_32x32x16_bf16 v[80:95], v[124:127], v[116:119], v[80:95]
  s_barrier
  s_waitcnt lgkmcnt(0)
  v_mfma_f32_32x32x16_bf16 v[32:47], v[136:139], v[128:131], v[32:47]
  ds_read_b128 v[96:99], v4 offset:57344
  ds_read_b64_tr_b16 v[104:105], v6 offset:32768
  ds_read_b64_tr_b16 v[106:107], v6 offset:33280
  v_mfma_f32_32x32x16_bf16 v[48:63], v[140:143], v[128:131], v[48:63]
  ds_read_b128 v[100:103], v4 offset:59392
  ds_read_b64_tr_b16 v[108:109], v9 offset:32768
  ds_read_b64_tr_b16 v[110:111], v9 offset:33280
  v_mfma_f32_32x32x16_bf16 v[64:79], v[136:139], v[132:135], v[64:79]
  ds_read_b128 v[112:115], v4 offset:58368
  ds_read_b64_tr_b16 v[120:121], v6 offset:34816
  ds_read_b64_tr_b16 v[122:123], v6 offset:35328
  v_mfma_f32_32x32x16_bf16 v[80:95], v[140:143], v[132:135], v[80:95]
  ds_read_b128 v[116:119], v4 offset:60416
  ds_read_b64_tr_b16 v[124:125], v9 offset:34816
  ds_read_b64_tr_b16 v[126:127], v9 offset:35328
  v_mfma_f32_32x32x16_bf16 v[32:47], v[152:155], v[144:147], v[32:47]
  v_mfma_f32_32x32x16_bf16 v[48:63], v[156:159], v[144:147], v[48:63]
  v_mfma_f32_32x32x16_bf16 v[64:79], v[152:155], v[148:151], v[64:79]
  v_mfma_f32_32x32x16_bf16 v[80:95], v[156:159], v[148:151], v[80:95]
  s_barrier
  s_waitcnt lgkmcnt(0)
  v_mfma_f32_32x32x16_bf16 v[32:47], v[104:107], v[96:99], v[32:47]
  ds_read_b128 v[128:131], v5 offset:0
  ds_read_b64_tr_b16 v[136:137], v6 offset:40960
  ds_read_b64_tr_b16 v[138:139], v6 offset:41472
  v_mfma_f32_32x32x16_bf16 v[48:63], v[108:111], v[96:99], v[48:63]
  ds_read_b128 v[132:135], v5 offset:2048
  ds_read_b64_tr_b16 v[140:141], v9 offset:40960
  ds_read_b64_tr_b16 v[142:143], v9 offset:41472
  v_mfma_f32_32x32x16_bf16 v[64:79], v[104:107], v[100:103], v[64:79]
  ds_read_b128 v[144:147], v5 offset:1024
  ds_read_b64_tr_b16 v[152:153], v6 offset:43008
  ds_read_b64_tr_b16 v[154:155], v6 offset:43520
  v_mfma_f32_32x32x16_bf16 v[80:95], v[108:111], v[100:103], v[80:95]
  ds_read_b128 v[148:151], v5 offset:3072
  ds_read_b64_tr_b16 v[156:157], v9 offset:43008
  ds_read_b64_tr_b16 v[158:159], v9 offset:43520
  v_mfma_f32_32x32x16_bf16 v[32:47], v[120:123], v[112:115], v[32:47]
  v_mfma_f32_32x32x16_bf16 v[48:63], v[124:127], v[112:115], v[48:63]
  v_mfma_f32_32x32x16_bf16 v[64:79], v[120:123], v[116:119], v[64:79]
  v_mfma_f32_32x32x16_bf16 v[80:95], v[124:127], v[116:119], v[80:95]
  s_waitcnt lgkmcnt(0)
  s_barrier
  v_mfma_f32_32x32x16_bf16 v[32:47], v[136:139], v[128:131], v[32:47]
  v_mfma_f32_32x32x16_bf16 v[48:63], v[140:143], v[128:131], v[48:63]
  v_mfma_f32_32x32x16_bf16 v[64:79], v[136:139], v[132:135], v[64:79]
  v_mfma_f32_32x32x16_bf16 v[80:95], v[140:143], v[132:135], v[80:95]
  v_mfma_f32_32x32x16_bf16 v[32:47], v[152:155], v[144:147], v[32:47]
  v_mfma_f32_32x32x16_bf16 v[48:63], v[156:159], v[144:147], v[48:63]
  v_mfma_f32_32x32x16_bf16 v[64:79], v[152:155], v[148:151], v[64:79]
  v_mfma_f32_32x32x16_bf16 v[80:95], v[156:159], v[148:151], v[80:95]
  s_waitcnt vmcnt(0)
  v_lshlrev_b32 v17, 3, v12
  s_lshl_b32 s40, s30, 9
  s_add_u32 s40, s40, 156160
  v_add_u32 v17, s40, v17
  ds_read_b64 v[232:233], v17
  ds_read_b64 v[234:235], v17 offset:256
  v_lshlrev_b32 v16, 5, v14
  s_lshl_b32 s40, s31, 8
  s_add_u32 s40, s40, 155648
  v_add_u32 v16, s40, v16
  ds_read_b128 v[96:99], v16 offset:0
  ds_read_b128 v[100:103], v16 offset:16
  ds_read_b128 v[104:107], v16 offset:64
  ds_read_b128 v[108:111], v16 offset:80
  ds_read_b128 v[112:115], v16 offset:128
  ds_read_b128 v[116:119], v16 offset:144
  ds_read_b128 v[120:123], v16 offset:192
  ds_read_b128 v[124:127], v16 offset:208
  v_lshlrev_b32 v128, 16, v160
  v_and_b32 v129, 0xffff0000, v160
  v_lshlrev_b32 v130, 16, v161
  v_and_b32 v131, 0xffff0000, v161
  v_lshlrev_b32 v132, 16, v162
  v_and_b32 v133, 0xffff0000, v162
  v_lshlrev_b32 v134, 16, v163
  v_and_b32 v135, 0xffff0000, v163
  v_lshlrev_b32 v136, 16, v164
  v_and_b32 v137, 0xffff0000, v164
  v_lshlrev_b32 v138, 16, v165
  v_and_b32 v139, 0xffff0000, v165
  v_lshlrev_b32 v140, 16, v166
  v_and_b32 v141, 0xffff0000, v166
  v_lshlrev_b32 v142, 16, v167
  v_and_b32 v143, 0xffff0000, v167
  v_lshlrev_b32 v144, 16, v168
  v_and_b32 v145, 0xffff0000, v168
  v_lshlrev_b32 v146, 16, v169
  v_and_b32 v147, 0xffff0000, v169
  v_lshlrev_b32 v148, 16, v170
  v_and_b32 v149, 0xffff0000, v170
  v_lshlrev_b32 v150, 16, v171
  v_and_b32 v151, 0xffff0000, v171
  v_lshlrev_b32 v152, 16, v172
  v_and_b32 v153, 0xffff0000, v172
  v_lshlrev_b32 v154, 16, v173
  v_and_b32 v155, 0xffff0000, v173
  v_lshlrev_b32 v156, 16, v174
  v_and_b32 v157, 0xffff0000, v174
  v_lshlrev_b32 v158, 16, v175
  v_and_b32 v159, 0xffff0000, v175
  s_mov_b32 s44, 0xc0135761
  s_mov_b32 s46, 0xbdd2d3e8
  v_mov_b32 v24, s44
  v_mov_b32 v25, s44
  s_mul_i32 s40, s38, 112
  s_lshl_b32 s41, s39, 1
  s_add_u32 s40, s40, s41
  s_lshl_b32 s40, s40, 10
  s_waitcnt lgkmcnt(0)
  v_pk_fma_f32 v[176:177], v[232:233], v[96:97], v[128:129] op_sel:[1,0,0] op_sel_hi:[1,1,1]
  v_pk_fma_f32 v[178:179], v[232:233], v[98:99], v[130:131] op_sel:[1,0,0] op_sel_hi:[1,1,1]
  v_pk_fma_f32 v[180:181], v[232:233], v[100:101], v[132:133] op_sel:[1,0,0] op_sel_hi:[1,1,1]
  v_pk_fma_f32 v[182:183], v[232:233], v[102:103], v[134:135] op_sel:[1,0,0] op_sel_hi:[1,1,1]
  v_pk_fma_f32 v[32:33], v[32:33], v[232:233], v[176:177] op_sel:[0,0,0] op_sel_hi:[1,0,1]
  v_pk_fma_f32 v[34:35], v[34:35], v[232:233], v[178:179] op_sel:[0,0,0] op_sel_hi:[1,0,1]
  v_pk_fma_f32 v[36:37], v[36:37], v[232:233], v[180:181] op_sel:[0,0,0] op_sel_hi:[1,0,1]
  v_pk_fma_f32 v[38:39], v[38:39], v[232:233], v[182:183] op_sel:[0,0,0] op_sel_hi:[1,0,1]
  v_pk_mul_f32 v[176:177], v[32:33], v[32:33]
  v_pk_mul_f32 v[178:179], v[34:35], v[34:35]
  v_pk_mul_f32 v[180:181], v[36:37], v[36:37]
  v_pk_mul_f32 v[182:183], v[38:39], v[38:39]
  v_pk_fma_f32 v[176:177], v[176:177], s[46:47], v[24:25] op_sel_hi:[1,0,1]
  v_pk_fma_f32 v[178:179], v[178:179], s[46:47], v[24:25] op_sel_hi:[1,0,1]
  v_pk_fma_f32 v[180:181], v[180:181], s[46:47], v[24:25] op_sel_hi:[1,0,1]
  v_pk_fma_f32 v[182:183], v[182:183], s[46:47], v[24:25] op_sel_hi:[1,0,1]
  v_pk_mul_f32 v[176:177], v[176:177], v[32:33]
  v_pk_mul_f32 v[178:179], v[178:179], v[34:35]
  v_pk_mul_f32 v[180:181], v[180:181], v[36:37]
  v_pk_mul_f32 v[182:183], v[182:183], v[38:39]
  v_exp_f32 v176, v176
  v_exp_f32 v177, v177
  v_exp_f32 v178, v178
  v_exp_f32 v179, v179
  v_exp_f32 v180, v180
  v_exp_f32 v181, v181
  v_exp_f32 v182, v182
  v_exp_f32 v183, v183
  v_pk_add_f32 v[176:177], v[176:177], 1.0 op_sel_hi:[1,0]
  v_pk_add_f32 v[178:179], v[178:179], 1.0 op_sel_hi:[1,0]
  v_pk_add_f32 v[180:181], v[180:181], 1.0 op_sel_hi:[1,0]
  v_pk_add_f32 v[182:183], v[182:183], 1.0 op_sel_hi:[1,0]
  v_rcp_f32 v176, v176
  v_rcp_f32 v177, v177
  v_rcp_f32 v178, v178
  v_rcp_f32 v179, v179
  v_rcp_f32 v180, v180
  v_rcp_f32 v181, v181
  v_rcp_f32 v182, v182
  v_rcp_f32 v183, v183
  v_pk_mul_f32 v[32:33], v[32:33], v[176:177]
  v_pk_mul_f32 v[34:35], v[34:35], v[178:179]
  v_pk_mul_f32 v[36:37], v[36:37], v[180:181]
  v_pk_mul_f32 v[38:39], v[38:39], v[182:183]
  v_cvt_pk_bf16_f32 v184, v32, v33
  v_cvt_pk_bf16_f32 v185, v34, v35
  v_cvt_pk_bf16_f32 v186, v36, v37
  v_cvt_pk_bf16_f32 v187, v38, v39
  s_add_u32 s41, s40, 0
  buffer_store_dwordx4 v[184:187], v2, s[16:19], s41 offen sc1
  v_pk_fma_f32 v[176:177], v[232:233], v[104:105], v[136:137] op_sel:[1,0,0] op_sel_hi:[1,1,1]
  v_pk_fma_f32 v[178:179], v[232:233], v[106:107], v[138:139] op_sel:[1,0,0] op_sel_hi:[1,1,1]
  v_pk_fma_f32 v[180:181], v[232:233], v[108:109], v[140:141] op_sel:[1,0,0] op_sel_hi:[1,1,1]
  v_pk_fma_f32 v[182:183], v[232:233], v[110:111], v[142:143] op_sel:[1,0,0] op_sel_hi:[1,1,1]
  v_pk_fma_f32 v[40:41], v[40:41], v[232:233], v[176:177] op_sel:[0,0,0] op_sel_hi:[1,0,1]
  v_pk_fma_f32 v[42:43], v[42:43], v[232:233], v[178:179] op_sel:[0,0,0] op_sel_hi:[1,0,1]
  v_pk_fma_f32 v[44:45], v[44:45], v[232:233], v[180:181] op_sel:[0,0,0] op_sel_hi:[1,0,1]
  v_pk_fma_f32 v[46:47], v[46:47], v[232:233], v[182:183] op_sel:[0,0,0] op_sel_hi:[1,0,1]
  v_pk_mul_f32 v[176:177], v[40:41], v[40:41]
  v_pk_mul_f32 v[178:179], v[42:43], v[42:43]
  v_pk_mul_f32 v[180:181], v[44:45], v[44:45]
  v_pk_mul_f32 v[182:183], v[46:47], v[46:47]
  v_pk_fma_f32 v[176:177], v[176:177], s[46:47], v[24:25] op_sel_hi:[1,0,1]
  v_pk_fma_f32 v[178:179], v[178:179], s[46:47], v[24:25] op_sel_hi:[1,0,1]
  v_pk_fma_f32 v[180:181], v[180:181], s[46:47], v[24:25] op_sel_hi:[1,0,1]
  v_pk_fma_f32 v[182:183], v[182:183], s[46:47], v[24:25] op_sel_hi:[1,0,1]
  v_pk_mul_f32 v[176:177], v[176:177], v[40:41]
  v_pk_mul_f32 v[178:179], v[178:179], v[42:43]
  v_pk_mul_f32 v[180:181], v[180:181], v[44:45]
  v_pk_mul_f32 v[182:183], v[182:183], v[46:47]
  v_exp_f32 v176, v176
  v_exp_f32 v177, v177
  v_exp_f32 v178, v178
  v_exp_f32 v179, v179
  v_exp_f32 v180, v180
  v_exp_f32 v181, v181
  v_exp_f32 v182, v182
  v_exp_f32 v183, v183
  v_pk_add_f32 v[176:177], v[176:177], 1.0 op_sel_hi:[1,0]
  v_pk_add_f32 v[178:179], v[178:179], 1.0 op_sel_hi:[1,0]
  v_pk_add_f32 v[180:181], v[180:181], 1.0 op_sel_hi:[1,0]
  v_pk_add_f32 v[182:183], v[182:183], 1.0 op_sel_hi:[1,0]
  v_rcp_f32 v176, v176
  v_rcp_f32 v177, v177
  v_rcp_f32 v178, v178
  v_rcp_f32 v179, v179
  v_rcp_f32 v180, v180
  v_rcp_f32 v181, v181
  v_rcp_f32 v182, v182
  v_rcp_f32 v183, v183
  v_pk_mul_f32 v[40:41], v[40:41], v[176:177]
  v_pk_mul_f32 v[42:43], v[42:43], v[178:179]
  v_pk_mul_f32 v[44:45], v[44:45], v[180:181]
  v_pk_mul_f32 v[46:47], v[46:47], v[182:183]
  v_cvt_pk_bf16_f32 v188, v40, v41
  v_cvt_pk_bf16_f32 v189, v42, v43
  v_cvt_pk_bf16_f32 v190, v44, v45
  v_cvt_pk_bf16_f32 v191, v46, v47
  s_add_u32 s41, s40, 1024
  buffer_store_dwordx4 v[188:191], v2, s[16:19], s41 offen sc1
  v_pk_fma_f32 v[176:177], v[232:233], v[112:113], v[144:145] op_sel:[1,0,0] op_sel_hi:[1,1,1]
  v_pk_fma_f32 v[178:179], v[232:233], v[114:115], v[146:147] op_sel:[1,0,0] op_sel_hi:[1,1,1]
  v_pk_fma_f32 v[180:181], v[232:233], v[116:117], v[148:149] op_sel:[1,0,0] op_sel_hi:[1,1,1]
  v_pk_fma_f32 v[182:183], v[232:233], v[118:119], v[150:151] op_sel:[1,0,0] op_sel_hi:[1,1,1]
  v_pk_fma_f32 v[48:49], v[48:49], v[232:233], v[176:177] op_sel:[0,0,0] op_sel_hi:[1,0,1]
  v_pk_fma_f32 v[50:51], v[50:51], v[232:233], v[178:179] op_sel:[0,0,0] op_sel_hi:[1,0,1]
  v_pk_fma_f32 v[52:53], v[52:53], v[232:233], v[180:181] op_sel:[0,0,0] op_sel_hi:[1,0,1]
  v_pk_fma_f32 v[54:55], v[54:55], v[232:233], v[182:183] op_sel:[0,0,0] op_sel_hi:[1,0,1]
  v_pk_mul_f32 v[176:177], v[48:49], v[48:49]
  v_pk_mul_f32 v[178:179], v[50:51], v[50:51]
  v_pk_mul_f32 v[180:181], v[52:53], v[52:53]
  v_pk_mul_f32 v[182:183], v[54:55], v[54:55]
  v_pk_fma_f32 v[176:177], v[176:177], s[46:47], v[24:25] op_sel_hi:[1,0,1]
  v_pk_fma_f32 v[178:179], v[178:179], s[46:47], v[24:25] op_sel_hi:[1,0,1]
  v_pk_fma_f32 v[180:181], v[180:181], s[46:47], v[24:25] op_sel_hi:[1,0,1]
  v_pk_fma_f32 v[182:183], v[182:183], s[46:47], v[24:25] op_sel_hi:[1,0,1]
  v_pk_mul_f32 v[176:177], v[176:177], v[48:49]
  v_pk_mul_f32 v[178:179], v[178:179], v[50:51]
  v_pk_mul_f32 v[180:181], v[180:181], v[52:53]
  v_pk_mul_f32 v[182:183], v[182:183], v[54:55]
  v_exp_f32 v176, v176
  v_exp_f32 v177, v177
  v_exp_f32 v178, v178
  v_exp_f32 v179, v179
  v_exp_f32 v180, v180
  v_exp_f32 v181, v181
  v_exp_f32 v182, v182
  v_exp_f32 v183, v183
  v_pk_add_f32 v[176:177], v[176:177], 1.0 op_sel_hi:[1,0]
  v_pk_add_f32 v[178:179], v[178:179], 1.0 op_sel_hi:[1,0]
  v_pk_add_f32 v[180:181], v[180:181], 1.0 op_sel_hi:[1,0]
  v_pk_add_f32 v[182:183], v[182:183], 1.0 op_sel_hi:[1,0]
  v_rcp_f32 v176, v176
  v_rcp_f32 v177, v177
  v_rcp_f32 v178, v178
  v_rcp_f32 v179, v179
  v_rcp_f32 v180, v180
  v_rcp_f32 v181, v181
  v_rcp_f32 v182, v182
  v_rcp_f32 v183, v183
  v_pk_mul_f32 v[48:49], v[48:49], v[176:177]
  v_pk_mul_f32 v[50:51], v[50:51], v[178:179]
  v_pk_mul_f32 v[52:53], v[52:53], v[180:181]
  v_pk_mul_f32 v[54:55], v[54:55], v[182:183]
  v_cvt_pk_bf16_f32 v192, v48, v49
  v_cvt_pk_bf16_f32 v193, v50, v51
  v_cvt_pk_bf16_f32 v194, v52, v53
  v_cvt_pk_bf16_f32 v195, v54, v55
  s_add_u32 s41, s40, 2048
  buffer_store_dwordx4 v[192:195], v2, s[16:19], s41 offen sc1
  v_pk_fma_f32 v[176:177], v[232:233], v[120:121], v[152:153] op_sel:[1,0,0] op_sel_hi:[1,1,1]
  v_pk_fma_f32 v[178:179], v[232:233], v[122:123], v[154:155] op_sel:[1,0,0] op_sel_hi:[1,1,1]
  v_pk_fma_f32 v[180:181], v[232:233], v[124:125], v[156:157] op_sel:[1,0,0] op_sel_hi:[1,1,1]
  v_pk_fma_f32 v[182:183], v[232:233], v[126:127], v[158:159] op_sel:[1,0,0] op_sel_hi:[1,1,1]
  v_pk_fma_f32 v[56:57], v[56:57], v[232:233], v[176:177] op_sel:[0,0,0] op_sel_hi:[1,0,1]
  v_pk_fma_f32 v[58:59], v[58:59], v[232:233], v[178:179] op_sel:[0,0,0] op_sel_hi:[1,0,1]
  v_pk_fma_f32 v[60:61], v[60:61], v[232:233], v[180:181] op_sel:[0,0,0] op_sel_hi:[1,0,1]
  v_pk_fma_f32 v[62:63], v[62:63], v[232:233], v[182:183] op_sel:[0,0,0] op_sel_hi:[1,0,1]
  v_pk_mul_f32 v[176:177], v[56:57], v[56:57]
  v_pk_mul_f32 v[178:179], v[58:59], v[58:59]
  v_pk_mul_f32 v[180:181], v[60:61], v[60:61]
  v_pk_mul_f32 v[182:183], v[62:63], v[62:63]
  v_pk_fma_f32 v[176:177], v[176:177], s[46:47], v[24:25] op_sel_hi:[1,0,1]
  v_pk_fma_f32 v[178:179], v[178:179], s[46:47], v[24:25] op_sel_hi:[1,0,1]
  v_pk_fma_f32 v[180:181], v[180:181], s[46:47], v[24:25] op_sel_hi:[1,0,1]
  v_pk_fma_f32 v[182:183], v[182:183], s[46:47], v[24:25] op_sel_hi:[1,0,1]
  v_pk_mul_f32 v[176:177], v[176:177], v[56:57]
  v_pk_mul_f32 v[178:179], v[178:179], v[58:59]
  v_pk_mul_f32 v[180:181], v[180:181], v[60:61]
  v_pk_mul_f32 v[182:183], v[182:183], v[62:63]
  v_exp_f32 v176, v176
  v_exp_f32 v177, v177
  v_exp_f32 v178, v178
  v_exp_f32 v179, v179
  v_exp_f32 v180, v180
  v_exp_f32 v181, v181
  v_exp_f32 v182, v182
  v_exp_f32 v183, v183
  v_pk_add_f32 v[176:177], v[176:177], 1.0 op_sel_hi:[1,0]
  v_pk_add_f32 v[178:179], v[178:179], 1.0 op_sel_hi:[1,0]
  v_pk_add_f32 v[180:181], v[180:181], 1.0 op_sel_hi:[1,0]
  v_pk_add_f32 v[182:183], v[182:183], 1.0 op_sel_hi:[1,0]
  v_rcp_f32 v176, v176
  v_rcp_f32 v177, v177
  v_rcp_f32 v178, v178
  v_rcp_f32 v179, v179
  v_rcp_f32 v180, v180
  v_rcp_f32 v181, v181
  v_rcp_f32 v182, v182
  v_rcp_f32 v183, v183
  v_pk_mul_f32 v[56:57], v[56:57], v[176:177]
  v_pk_mul_f32 v[58:59], v[58:59], v[178:179]
  v_pk_mul_f32 v[60:61], v[60:61], v[180:181]
  v_pk_mul_f32 v[62:63], v[62:63], v[182:183]
  v_cvt_pk_bf16_f32 v196, v56, v57
  v_cvt_pk_bf16_f32 v197, v58, v59
  v_cvt_pk_bf16_f32 v198, v60, v61
  v_cvt_pk_bf16_f32 v199, v62, v63
  s_add_u32 s41, s40, 3072
  buffer_store_dwordx4 v[196:199], v2, s[16:19], s41 offen sc1
  v_pk_fma_f32 v[176:177], v[234:235], v[96:97], v[128:129] op_sel:[1,0,0] op_sel_hi:[1,1,1]
  v_pk_fma_f32 v[178:179], v[234:235], v[98:99], v[130:131] op_sel:[1,0,0] op_sel_hi:[1,1,1]
  v_pk_fma_f32 v[180:181], v[234:235], v[100:101], v[132:133] op_sel:[1,0,0] op_sel_hi:[1,1,1]
  v_pk_fma_f32 v[182:183], v[234:235], v[102:103], v[134:135] op_sel:[1,0,0] op_sel_hi:[1,1,1]
  v_pk_fma_f32 v[64:65], v[64:65], v[234:235], v[176:177] op_sel:[0,0,0] op_sel_hi:[1,0,1]
  v_pk_fma_f32 v[66:67], v[66:67], v[234:235], v[178:179] op_sel:[0,0,0] op_sel_hi:[1,0,1]
  v_pk_fma_f32 v[68:69], v[68:69], v[234:235], v[180:181] op_sel:[0,0,0] op_sel_hi:[1,0,1]
  v_pk_fma_f32 v[70:71], v[70:71], v[234:235], v[182:183] op_sel:[0,0,0] op_sel_hi:[1,0,1]
  v_pk_mul_f32 v[176:177], v[64:65], v[64:65]
  v_pk_mul_f32 v[178:179], v[66:67], v[66:67]
  v_pk_mul_f32 v[180:181], v[68:69], v[68:69]
  v_pk_mul_f32 v[182:183], v[70:71], v[70:71]
  v_pk_fma_f32 v[176:177], v[176:177], s[46:47], v[24:25] op_sel_hi:[1,0,1]
  v_pk_fma_f32 v[178:179], v[178:179], s[46:47], v[24:25] op_sel_hi:[1,0,1]
  v_pk_fma_f32 v[180:181], v[180:181], s[46:47], v[24:25] op_sel_hi:[1,0,1]
  v_pk_fma_f32 v[182:183], v[182:183], s[46:47], v[24:25] op_sel_hi:[1,0,1]
  v_pk_mul_f32 v[176:177], v[176:177], v[64:65]
  v_pk_mul_f32 v[178:179], v[178:179], v[66:67]
  v_pk_mul_f32 v[180:181], v[180:181], v[68:69]
  v_pk_mul_f32 v[182:183], v[182:183], v[70:71]
  v_exp_f32 v176, v176
  v_exp_f32 v177, v177
  v_exp_f32 v178, v178
  v_exp_f32 v179, v179
  v_exp_f32 v180, v180
  v_exp_f32 v181, v181
  v_exp_f32 v182, v182
  v_exp_f32 v183, v183
  v_pk_add_f32 v[176:177], v[176:177], 1.0 op_sel_hi:[1,0]
  v_pk_add_f32 v[178:179], v[178:179], 1.0 op_sel_hi:[1,0]
  v_pk_add_f32 v[180:181], v[180:181], 1.0 op_sel_hi:[1,0]
  v_pk_add_f32 v[182:183], v[182:183], 1.0 op_sel_hi:[1,0]
  v_rcp_f32 v176, v176
  v_rcp_f32 v177, v177
  v_rcp_f32 v178, v178
  v_rcp_f32 v179, v179
  v_rcp_f32 v180, v180
  v_rcp_f32 v181, v181
  v_rcp_f32 v182, v182
  v_rcp_f32 v183, v183
  v_pk_mul_f32 v[64:65], v[64:65], v[176:177]
  v_pk_mul_f32 v[66:67], v[66:67], v[178:179]
  v_pk_mul_f32 v[68:69], v[68:69], v[180:181]
  v_pk_mul_f32 v[70:71], v[70:71], v[182:183]
  v_cvt_pk_bf16_f32 v184, v64, v65
  v_cvt_pk_bf16_f32 v185, v66, v67
  v_cvt_pk_bf16_f32 v186, v68, v69
  v_cvt_pk_bf16_f32 v187, v70, v71
  s_add_u32 s41, s40, 114688
  buffer_store_dwordx4 v[184:187], v2, s[16:19], s41 offen sc1
  v_pk_fma_f32 v[176:177], v[234:235], v[104:105], v[136:137] op_sel:[1,0,0] op_sel_hi:[1,1,1]
  v_pk_fma_f32 v[178:179], v[234:235], v[106:107], v[138:139] op_sel:[1,0,0] op_sel_hi:[1,1,1]
  v_pk_fma_f32 v[180:181], v[234:235], v[108:109], v[140:141] op_sel:[1,0,0] op_sel_hi:[1,1,1]
  v_pk_fma_f32 v[182:183], v[234:235], v[110:111], v[142:143] op_sel:[1,0,0] op_sel_hi:[1,1,1]
  v_pk_fma_f32 v[72:73], v[72:73], v[234:235], v[176:177] op_sel:[0,0,0] op_sel_hi:[1,0,1]
  v_pk_fma_f32 v[74:75], v[74:75], v[234:235], v[178:179] op_sel:[0,0,0] op_sel_hi:[1,0,1]
  v_pk_fma_f32 v[76:77], v[76:77], v[234:235], v[180:181] op_sel:[0,0,0] op_sel_hi:[1,0,1]
  v_pk_fma_f32 v[78:79], v[78:79], v[234:235], v[182:183] op_sel:[0,0,0] op_sel_hi:[1,0,1]
  v_pk_mul_f32 v[176:177], v[72:73], v[72:73]
  v_pk_mul_f32 v[178:179], v[74:75], v[74:75]
  v_pk_mul_f32 v[180:181], v[76:77], v[76:77]
  v_pk_mul_f32 v[182:183], v[78:79], v[78:79]
  v_pk_fma_f32 v[176:177], v[176:177], s[46:47], v[24:25] op_sel_hi:[1,0,1]
  v_pk_fma_f32 v[178:179], v[178:179], s[46:47], v[24:25] op_sel_hi:[1,0,1]
  v_pk_fma_f32 v[180:181], v[180:181], s[46:47], v[24:25] op_sel_hi:[1,0,1]
  v_pk_fma_f32 v[182:183], v[182:183], s[46:47], v[24:25] op_sel_hi:[1,0,1]
  v_pk_mul_f32 v[176:177], v[176:177], v[72:73]
  v_pk_mul_f32 v[178:179], v[178:179], v[74:75]
  v_pk_mul_f32 v[180:181], v[180:181], v[76:77]
  v_pk_mul_f32 v[182:183], v[182:183], v[78:79]
  v_exp_f32 v176, v176
  v_exp_f32 v177, v177
  v_exp_f32 v178, v178
  v_exp_f32 v179, v179
  v_exp_f32 v180, v180
  v_exp_f32 v181, v181
  v_exp_f32 v182, v182
  v_exp_f32 v183, v183
  v_pk_add_f32 v[176:177], v[176:177], 1.0 op_sel_hi:[1,0]
  v_pk_add_f32 v[178:179], v[178:179], 1.0 op_sel_hi:[1,0]
  v_pk_add_f32 v[180:181], v[180:181], 1.0 op_sel_hi:[1,0]
  v_pk_add_f32 v[182:183], v[182:183], 1.0 op_sel_hi:[1,0]
  v_rcp_f32 v176, v176
  v_rcp_f32 v177, v177
  v_rcp_f32 v178, v178
  v_rcp_f32 v179, v179
  v_rcp_f32 v180, v180
  v_rcp_f32 v181, v181
  v_rcp_f32 v182, v182
  v_rcp_f32 v183, v183
  v_pk_mul_f32 v[72:73], v[72:73], v[176:177]
  v_pk_mul_f32 v[74:75], v[74:75], v[178:179]
  v_pk_mul_f32 v[76:77], v[76:77], v[180:181]
  v_pk_mul_f32 v[78:79], v[78:79], v[182:183]
  v_cvt_pk_bf16_f32 v188, v72, v73
  v_cvt_pk_bf16_f32 v189, v74, v75
  v_cvt_pk_bf16_f32 v190, v76, v77
  v_cvt_pk_bf16_f32 v191, v78, v79
  s_add_u32 s41, s40, 115712
  buffer_store_dwordx4 v[188:191], v2, s[16:19], s41 offen sc1
  v_pk_fma_f32 v[176:177], v[234:235], v[112:113], v[144:145] op_sel:[1,0,0] op_sel_hi:[1,1,1]
  v_pk_fma_f32 v[178:179], v[234:235], v[114:115], v[146:147] op_sel:[1,0,0] op_sel_hi:[1,1,1]
  v_pk_fma_f32 v[180:181], v[234:235], v[116:117], v[148:149] op_sel:[1,0,0] op_sel_hi:[1,1,1]
  v_pk_fma_f32 v[182:183], v[234:235], v[118:119], v[150:151] op_sel:[1,0,0] op_sel_hi:[1,1,1]
  v_pk_fma_f32 v[80:81], v[80:81], v[234:235], v[176:177] op_sel:[0,0,0] op_sel_hi:[1,0,1]
  v_pk_fma_f32 v[82:83], v[82:83], v[234:235], v[178:179] op_sel:[0,0,0] op_sel_hi:[1,0,1]
  v_pk_fma_f32 v[84:85], v[84:85], v[234:235], v[180:181] op_sel:[0,0,0] op_sel_hi:[1,0,1]
  v_pk_fma_f32 v[86:87], v[86:87], v[234:235], v[182:183] op_sel:[0,0,0] op_sel_hi:[1,0,1]
  v_pk_mul_f32 v[176:177], v[80:81], v[80:81]
  v_pk_mul_f32 v[178:179], v[82:83], v[82:83]
  v_pk_mul_f32 v[180:181], v[84:85], v[84:85]
  v_pk_mul_f32 v[182:183], v[86:87], v[86:87]
  v_pk_fma_f32 v[176:177], v[176:177], s[46:47], v[24:25] op_sel_hi:[1,0,1]
  v_pk_fma_f32 v[178:179], v[178:179], s[46:47], v[24:25] op_sel_hi:[1,0,1]
  v_pk_fma_f32 v[180:181], v[180:181], s[46:47], v[24:25] op_sel_hi:[1,0,1]
  v_pk_fma_f32 v[182:183], v[182:183], s[46:47], v[24:25] op_sel_hi:[1,0,1]
  v_pk_mul_f32 v[176:177], v[176:177], v[80:81]
  v_pk_mul_f32 v[178:179], v[178:179], v[82:83]
  v_pk_mul_f32 v[180:181], v[180:181], v[84:85]
  v_pk_mul_f32 v[182:183], v[182:183], v[86:87]
  v_exp_f32 v176, v176
  v_exp_f32 v177, v177
  v_exp_f32 v178, v178
  v_exp_f32 v179, v179
  v_exp_f32 v180, v180
  v_exp_f32 v181, v181
  v_exp_f32 v182, v182
  v_exp_f32 v183, v183
  v_pk_add_f32 v[176:177], v[176:177], 1.0 op_sel_hi:[1,0]
  v_pk_add_f32 v[178:179], v[178:179], 1.0 op_sel_hi:[1,0]
  v_pk_add_f32 v[180:181], v[180:181], 1.0 op_sel_hi:[1,0]
  v_pk_add_f32 v[182:183], v[182:183], 1.0 op_sel_hi:[1,0]
  v_rcp_f32 v176, v176
  v_rcp_f32 v177, v177
  v_rcp_f32 v178, v178
  v_rcp_f32 v179, v179
  v_rcp_f32 v180, v180
  v_rcp_f32 v181, v181
  v_rcp_f32 v182, v182
  v_rcp_f32 v183, v183
  v_pk_mul_f32 v[80:81], v[80:81], v[176:177]
  v_pk_mul_f32 v[82:83], v[82:83], v[178:179]
  v_pk_mul_f32 v[84:85], v[84:85], v[180:181]
  v_pk_mul_f32 v[86:87], v[86:87], v[182:183]
  v_cvt_pk_bf16_f32 v192, v80, v81
  v_cvt_pk_bf16_f32 v193, v82, v83
  v_cvt_pk_bf16_f32 v194, v84, v85
  v_cvt_pk_bf16_f32 v195, v86, v87
  s_add_u32 s41, s40, 116736
  buffer_store_dwordx4 v[192:195], v2, s[16:19], s41 offen sc1
  v_pk_fma_f32 v[176:177], v[234:235], v[120:121], v[152:153] op_sel:[1,0,0] op_sel_hi:[1,1,1]
  v_pk_fma_f32 v[178:179], v[234:235], v[122:123], v[154:155] op_sel:[1,0,0] op_sel_hi:[1,1,1]
  v_pk_fma_f32 v[180:181], v[234:235], v[124:125], v[156:157] op_sel:[1,0,0] op_sel_hi:[1,1,1]
  v_pk_fma_f32 v[182:183], v[234:235], v[126:127], v[158:159] op_sel:[1,0,0] op_sel_hi:[1,1,1]
  v_pk_fma_f32 v[88:89], v[88:89], v[234:235], v[176:177] op_sel:[0,0,0] op_sel_hi:[1,0,1]
  v_pk_fma_f32 v[90:91], v[90:91], v[234:235], v[178:179] op_sel:[0,0,0] op_sel_hi:[1,0,1]
  v_pk_fma_f32 v[92:93], v[92:93], v[234:235], v[180:181] op_sel:[0,0,0] op_sel_hi:[1,0,1]
  v_pk_fma_f32 v[94:95], v[94:95], v[234:235], v[182:183] op_sel:[0,0,0] op_sel_hi:[1,0,1]
  v_pk_mul_f32 v[176:177], v[88:89], v[88:89]
  v_pk_mul_f32 v[178:179], v[90:91], v[90:91]
  v_pk_mul_f32 v[180:181], v[92:93], v[92:93]
  v_pk_mul_f32 v[182:183], v[94:95], v[94:95]
  v_pk_fma_f32 v[176:177], v[176:177], s[46:47], v[24:25] op_sel_hi:[1,0,1]
  v_pk_fma_f32 v[178:179], v[178:179], s[46:47], v[24:25] op_sel_hi:[1,0,1]
  v_pk_fma_f32 v[180:181], v[180:181], s[46:47], v[24:25] op_sel_hi:[1,0,1]
  v_pk_fma_f32 v[182:183], v[182:183], s[46:47], v[24:25] op_sel_hi:[1,0,1]
  v_pk_mul_f32 v[176:177], v[176:177], v[88:89]
  v_pk_mul_f32 v[178:179], v[178:179], v[90:91]
  v_pk_mul_f32 v[180:181], v[180:181], v[92:93]
  v_pk_mul_f32 v[182:183], v[182:183], v[94:95]
  v_exp_f32 v176, v176
  v_exp_f32 v177, v177
  v_exp_f32 v178, v178
  v_exp_f32 v179, v179
  v_exp_f32 v180, v180
  v_exp_f32 v181, v181
  v_exp_f32 v182, v182
  v_exp_f32 v183, v183
  v_pk_add_f32 v[176:177], v[176:177], 1.0 op_sel_hi:[1,0]
  v_pk_add_f32 v[178:179], v[178:179], 1.0 op_sel_hi:[1,0]
  v_pk_add_f32 v[180:181], v[180:181], 1.0 op_sel_hi:[1,0]
  v_pk_add_f32 v[182:183], v[182:183], 1.0 op_sel_hi:[1,0]
  v_rcp_f32 v176, v176
  v_rcp_f32 v177, v177
  v_rcp_f32 v178, v178
  v_rcp_f32 v179, v179
  v_rcp_f32 v180, v180
  v_rcp_f32 v181, v181
  v_rcp_f32 v182, v182
  v_rcp_f32 v183, v183
  v_pk_mul_f32 v[88:89], v[88:89], v[176:177]
  v_pk_mul_f32 v[90:91], v[90:91], v[178:179]
  v_pk_mul_f32 v[92:93], v[92:93], v[180:181]
  v_pk_mul_f32 v[94:95], v[94:95], v[182:183]
  v_cvt_pk_bf16_f32 v196, v88, v89
  v_cvt_pk_bf16_f32 v197, v90, v91
  v_cvt_pk_bf16_f32 v198, v92, v93
  v_cvt_pk_bf16_f32 v199, v94, v95
  s_add_u32 s41, s40, 117760
  buffer_store_dwordx4 v[196:199], v2, s[16:19], s41 offen sc1
  s_barrier
  s_lshl_b32 s33, s25, 4
  s_add_u32 s33, s33, s26
  v_and_b32 v20, 31, v1
  v_lshlrev_b32 v20, 7, v20
  v_lshrrev_b32 v21, 5, v1
  v_mul_u32_u24 v21, 114688, v21
  v_add_u32 v20, v20, v21
  s_add_u32 s48, s84, 23068672
  s_addc_u32 s49, s85, 0
  s_and_b32 s49, s49, 0xffff
  s_mov_b32 s50, 135168
  s_mov_b32 s51, 0x20000
  s_add_u32 s46, s33, 768
  s_lshl_b32 s46, s46, 7
  v_mov_b32 v250, 163788
  v_mov_b32 v251, 1
  v_mov_b32 v253, s86
  v_mov_b32 v254, 0
  s_waitcnt vmcnt(0)
  s_mov_b64 exec, 1
  ds_add_rtn_u32 v251, v250, v251
  s_waitcnt lgkmcnt(0)
  v_readfirstlane_b32 s47, v251
  s_nop 3
  s_cmp_lg_u32 s47, 3
  s_cbranch_scc1 P4_arr_L_12
  buffer_store_dword v253, v254, s[48:51], s46 offen sc1
P4_arr_L_12:
  s_mov_b64 exec, -1
  s_branch P4_join
P4_prod:
  s_add_u32 s8, s84, 10485760
  s_addc_u32 s9, s85, 0
  s_and_b32 s9, s9, 0xffff
  s_mov_b32 s10, 2097152
  s_mov_b32 s11, 0x20000
  s_mov_b32 s12, s72
  s_and_b32 s13, s73, 0xffff
  s_mov_b32 s14, 1835008
  s_mov_b32 s15, 0x20000
  v_lshrrev_b32 v4, 3, v1
  s_mov_b32 s59, 3584
  v_mul_lo_u32 v3, v4, s59
  v_bfe_u32 v4, v1, 4, 1
  v_lshlrev_b32 v4, 2, v4
  v_and_b32 v5, 7, v1
  v_xor_b32 v4, v4, v5
  v_lshl_add_u32 v3, v4, 4, v3
  s_sub_u32 s29, s24, 4
  s_lshl_b32 s32, s25, 2
  s_add_u32 s32, s32, s29
  s_lshl_b32 s32, s32, 15
  s_lshl_b32 s33, s29, 11
  s_and_b32 s36, s29, 1
  s_lshr_b32 s37, s29, 1
  s_mul_i32 s34, s36, 57344
  s_lshl_b32 s35, s37, 7
  s_add_u32 s34, s34, s35
  s_lshl_b32 s35, s26, 8
  s_add_u32 s34, s34, s35
  s_lshl_b32 s35, s36, 11
  s_lshl_b32 s39, s37, 12
  s_add_u32 s35, s35, s39
  v_add_u32 v4, 27648, v3
  s_add_u32 m0, s35, 0
  s_add_u32 s36, s34, 0
  buffer_load_dwordx4 v3, s[12:15], s36 offen lds
  buffer_load_dwordx4 v4, s[12:15], s36 offen offset:1024 lds
  s_add_u32 m0, s35, 8192
  s_add_u32 s36, s34, 114688
  buffer_load_dwordx4 v3, s[12:15], s36 offen lds
  buffer_load_dwordx4 v4, s[12:15], s36 offen offset:1024 lds
  s_add_u32 m0, s35, 16384
  s_add_u32 s36, s34, 229376
  buffer_load_dwordx4 v3, s[12:15], s36 offen lds
  buffer_load_dwordx4 v4, s[12:15], s36 offen offset:1024 lds
  s_add_u32 m0, s35, 24576
  s_add_u32 s36, s34, 344064
  buffer_load_dwordx4 v3, s[12:15], s36 offen lds
  buffer_load_dwordx4 v4, s[12:15], s36 offen offset:1024 lds
  s_add_u32 m0, s35, 32768
  s_add_u32 s36, s34, 458752
  buffer_load_dwordx4 v3, s[12:15], s36 offen lds
  buffer_load_dwordx4 v4, s[12:15], s36 offen offset:1024 lds
  s_add_u32 m0, s35, 40960
  s_add_u32 s36, s34, 573440
  buffer_load_dwordx4 v3, s[12:15], s36 offen lds
  buffer_load_dwordx4 v4, s[12:15], s36 offen offset:1024 lds
  s_add_u32 m0, s35, 49152
  s_add_u32 s36, s34, 688128
  buffer_load_dwordx4 v3, s[12:15], s36 offen lds
  buffer_load_dwordx4 v4, s[12:15], s36 offen offset:1024 lds
  s_add_u32 m0, s35, 57344
  s_add_u32 s36, s34, 802816
  buffer_load_dwordx4 v3, s[12:15], s36 offen lds
  buffer_load_dwordx4 v4, s[12:15], s36 offen offset:1024 lds
  s_add_u32 m0, s35, 65536
  s_add_u32 s36, s34, 917504
  buffer_load_dwordx4 v3, s[12:15], s36 offen lds
  buffer_load_dwordx4 v4, s[12:15], s36 offen offset:1024 lds
  s_add_u32 m0, s35, 73728
  s_add_u32 s36, s34, 1032192
  buffer_load_dwordx4 v3, s[12:15], s36 offen lds
  buffer_load_dwordx4 v4, s[12:15], s36 offen offset:1024 lds
  s_barrier
  s_add_u32 s52, s84, 22020096
  s_addc_u32 s53, s85, 0
  s_and_b32 s53, s53, 0xffff
  s_mov_b32 s54, 262144
  s_mov_b32 s55, 0x20000
  v_lshlrev_b32 v13, 3, v1
  s_lshl_b32 s40, s25, 2
  s_add_u32 s40, s40, s29
  s_lshl_b32 s40, s40, 12
  s_add_u32 m0, s33, 81920
  s_add_u32 s36, s32, 0
  buffer_load_dwordx4 v2, s[8:11], s36 offen sc1 lds
  buffer_load_dwordx4 v2, s[8:11], s36 offen offset:1024 sc1 lds
  s_add_u32 m0, s33, 90112
  s_add_u32 s36, s32, 2048
  buffer_load_dwordx4 v2, s[8:11], s36 offen sc1 lds
  buffer_load_dwordx4 v2, s[8:11], s36 offen offset:1024 sc1 lds
  s_add_u32 m0, s33, 98304
  s_add_u32 s36, s32, 4096
  buffer_load_dwordx4 v2, s[8:11], s36 offen sc1 lds
  buffer_load_dwordx4 v2, s[8:11], s36 offen offset:1024 sc1 lds
  s_add_u32 m0, s33, 106496
  s_add_u32 s36, s32, 6144
  buffer_load_dwordx4 v2, s[8:11], s36 offen sc1 lds
  buffer_load_dwordx4 v2, s[8:11], s36 offen offset:1024 sc1 lds
  s_add_u32 m0, s33, 114688
  s_add_u32 s36, s32, 8192
  buffer_load_dwordx4 v2, s[8:11], s36 offen sc1 lds
  buffer_load_dwordx4 v2, s[8:11], s36 offen offset:1024 sc1 lds
  s_waitcnt vmcnt(8)
  s_barrier
  s_add_u32 m0, s33, 122880
  s_add_u32 s36, s32, 10240
  buffer_load_dwordx4 v2, s[8:11], s36 offen sc1 lds
  buffer_load_dwordx4 v2, s[8:11], s36 offen offset:1024 sc1 lds
  s_add_u32 m0, s33, 131072
  s_add_u32 s36, s32, 12288
  buffer_load_dwordx4 v2, s[8:11], s36 offen sc1 lds
  buffer_load_dwordx4 v2, s[8:11], s36 offen offset:1024 sc1 lds
  s_waitcnt vmcnt(10)
  s_barrier
  s_add_u32 m0, s33, 139264
  s_add_u32 s36, s32, 14336
  buffer_load_dwordx4 v2, s[8:11], s36 offen sc1 lds
  buffer_load_dwordx4 v2, s[8:11], s36 offen offset:1024 sc1 lds
  s_add_u32 m0, s33, 147456
  s_add_u32 s36, s32, 16384
  buffer_load_dwordx4 v2, s[8:11], s36 offen sc1 lds
  buffer_load_dwordx4 v2, s[8:11], s36 offen offset:1024 sc1 lds
  s_waitcnt vmcnt(12)
  s_barrier
  s_add_u32 m0, s33, 81920
  s_add_u32 s36, s32, 18432
  buffer_load_dwordx4 v2, s[8:11], s36 offen sc1 lds
  buffer_load_dwordx4 v2, s[8:11], s36 offen offset:1024 sc1 lds
  s_add_u32 m0, s35, 0
  s_add_u32 s36, s34, 1146880
  buffer_load_dwordx4 v3, s[12:15], s36 offen lds
  buffer_load_dwordx4 v4, s[12:15], s36 offen offset:1024 lds
  s_waitcnt vmcnt(14)
  s_barrier
  s_add_u32 m0, s33, 90112
  s_add_u32 s36, s32, 20480
  buffer_load_dwordx4 v2, s[8:11], s36 offen sc1 lds
  buffer_load_dwordx4 v2, s[8:11], s36 offen offset:1024 sc1 lds
  s_waitcnt vmcnt(14)
  s_barrier
  s_add_u32 m0, s33, 98304
  s_add_u32 s36, s32, 22528
  buffer_load_dwordx4 v2, s[8:11], s36 offen sc1 lds
  buffer_load_dwordx4 v2, s[8:11], s36 offen offset:1024 sc1 lds
  s_add_u32 m0, s35, 8192
  s_add_u32 s36, s34, 1261568
  buffer_load_dwordx4 v3, s[12:15], s36 offen lds
  buffer_load_dwordx4 v4, s[12:15], s36 offen offset:1024 lds
  s_waitcnt vmcnt(16)
  s_barrier
  s_add_u32 m0, s33, 106496
  s_add_u32 s36, s32, 24576
  buffer_load_dwordx4 v2, s[8:11], s36 offen sc1 lds
  buffer_load_dwordx4 v2, s[8:11], s36 offen offset:1024 sc1 lds
  s_waitcnt vmcnt(16)
  s_barrier
  s_add_u32 m0, s33, 114688
  s_add_u32 s36, s32, 26624
  buffer_load_dwordx4 v2, s[8:11], s36 offen sc1 lds
  buffer_load_dwordx4 v2, s[8:11], s36 offen offset:1024 sc1 lds
  s_add_u32 m0, s35, 16384
  s_add_u32 s36, s34, 1376256
  buffer_load_dwordx4 v3, s[12:15], s36 offen lds
  buffer_load_dwordx4 v4, s[12:15], s36 offen offset:1024 lds
  s_waitcnt vmcnt(18)
  s_barrier
  s_add_u32 m0, s33, 122880
  s_add_u32 s36, s32, 28672
  buffer_load_dwordx4 v2, s[8:11], s36 offen sc1 lds
  buffer_load_dwordx4 v2, s[8:11], s36 offen offset:1024 sc1 lds
  s_waitcnt vmcnt(18)
  s_barrier
  s_add_u32 m0, s33, 131072
  s_add_u32 s36, s32, 30720
  buffer_load_dwordx4 v2, s[8:11], s36 offen sc1 lds
  buffer_load_dwordx4 v2, s[8:11], s36 offen offset:1024 sc1 lds
  s_add_u32 m0, s35, 24576
  s_add_u32 s36, s34, 1490944
  buffer_load_dwordx4 v3, s[12:15], s36 offen lds
  buffer_load_dwordx4 v4, s[12:15], s36 offen offset:1024 lds
  s_waitcnt vmcnt(20)
  s_barrier
  s_add_u32 m0, s35, 32768
  s_add_u32 s36, s34, 1605632
  buffer_load_dwordx4 v3, s[12:15], s36 offen lds
  buffer_load_dwordx4 v4, s[12:15], s36 offen offset:1024 lds
  s_waitcnt vmcnt(18)
  s_barrier
  s_add_u32 m0, s35, 40960
  s_add_u32 s36, s34, 1720320
  buffer_load_dwordx4 v3, s[12:15], s36 offen lds
  buffer_load_dwordx4 v4, s[12:15], s36 offen offset:1024 lds
  buffer_load_dwordx2 v[64:65], v13, s[52:55], s40 offen offset:0 sc1
  buffer_load_dwordx2 v[66:67], v13, s[52:55], s40 offen offset:512 sc1
  buffer_load_dwordx2 v[68:69], v13, s[52:55], s40 offen offset:1024 sc1
  buffer_load_dwordx2 v[70:71], v13, s[52:55], s40 offen offset:1536 sc1
  s_waitcnt vmcnt(20)
  s_barrier
  buffer_load_dwordx2 v[72:73], v13, s[52:55], s40 offen offset:2048 sc1
  buffer_load_dwordx2 v[74:75], v13, s[52:55], s40 offen offset:2560 sc1
  buffer_load_dwordx2 v[76:77], v13, s[52:55], s40 offen offset:3072 sc1
  buffer_load_dwordx2 v[78:79], v13, s[52:55], s40 offen offset:3584 sc1
  s_waitcnt vmcnt(18)
  s_barrier
  s_waitcnt vmcnt(12)
  s_barrier
  s_waitcnt vmcnt(0)
  v_add_f32 v20, v64, v66
  v_add_f32 v21, v65, v67
  v_add_f32 v20, v20, v68
  v_add_f32 v21, v21, v69
  v_add_f32 v20, v20, v70
  v_add_f32 v21, v21, v71
  v_add_f32 v20, v20, v72
  v_add_f32 v21, v21, v73
  v_add_f32 v20, v20, v74
  v_add_f32 v21, v21, v75
  v_add_f32 v20, v20, v76
  v_add_f32 v21, v21, v77
  v_add_f32 v20, v20, v78
  v_add_f32 v21, v21, v79
  v_mov_b32 v22, v20
  v_mov_b32 v23, v21
  s_nop 1
  v_permlane32_swap_b32 v20, v22
  v_permlane32_swap_b32 v21, v23
  s_nop 1
  v_add_f32 v20, v20, v22
  v_add_f32 v21, v21, v23
  v_mul_f32 v20, 0x3b000000, v20
  v_mul_f32 v21, 0x3b000000, v21
  v_fma_f32 v21, -v20, v20, v21
  v_max_f32 v21, 0, v21
  v_add_f32 v21, 0x3727c5ac, v21
  v_rsq_f32 v22, v21
  s_nop 0
  v_mul_f32 v20, v20, v22
  v_sub_f32 v23, 0, v20
  v_and_b32 v24, 31, v1
  v_lshlrev_b32 v24, 3, v24
  s_lshl_b32 s41, s29, 8
  s_add_u32 s41, s41, 156160
  v_add_u32 v24, s41, v24
  ds_write_b64 v24, v[22:23]
  s_waitcnt vmcnt(10)
  s_barrier
  s_waitcnt vmcnt(8)
  s_barrier
  s_waitcnt lgkmcnt(0)
  s_cmp_lg_u32 s24, 7
  s_cbranch_scc1 P4cs_L_13
  s_lshl_b32 s40, s26, 1
  s_add_u32 s48, s84, 23068672
  s_addc_u32 s49, s85, 0
  s_and_b32 s49, s49, 0xffff
  s_mov_b32 s50, 135168
  s_mov_b32 s51, 0x20000
  s_add_u32 s46, s40, 1024
  s_lshl_b32 s46, s46, 7
  v_lshlrev_b32 v250, 7, v1
  s_mov_b32 s47, 100000
  s_mov_b64 exec, 0x3
  s_waitcnt vmcnt(0)
  buffer_load_dword v251, v250, s[48:51], s46 offen sc1
  s_sleep 4
P4_poll_L_14:
  buffer_load_dword v253, v250, s[48:51], s46 offen sc1
  s_waitcnt vmcnt(1)
  v_cmp_ne_u32 vcc, s86, v251
  s_nop 4
  s_and_b64 exec, exec, vcc
  s_cbranch_execz P4_poll_L_14_ok
  buffer_load_dword v251, v250, s[48:51], s46 offen sc1
  s_waitcnt vmcnt(1)
  v_cmp_ne_u32 vcc, s86, v253
  s_nop 4
  s_and_b64 exec, exec, vcc
  s_cbranch_execz P4_poll_L_14_ok
  s_sub_u32 s47, s47, 1
  s_cmp_eq_u32 s47, 0
  s_cbranch_scc0 P4_poll_L_14
P4_poll_L_14_ok:
  s_mov_b64 exec, -1
  s_add_u32 s52, s84, 21037056
  s_addc_u32 s53, s85, 0
  s_and_b32 s53, s53, 0xffff
  s_mov_b32 s54, 7168
  s_mov_b32 s55, 0x20000
  s_lshl_b32 s40, s26, 9
  s_mov_b32 m0, 155648
  s_mov_b32 exec_hi, 0
  buffer_load_dwordx4 v2, s[52:55], s40 offen sc1 lds
  s_mov_b64 exec, -1
  s_waitcnt vmcnt(0)
P4cs_L_13:
  s_barrier
  s_barrier
  s_branch P4_join
P4_join:
  s_and_b32 s27, s2, 7
  s_lshr_b32 s28, s2, 3
  s_lshl_b32 s25, s27, 2
  s_lshr_b32 s29, s28, 3
  s_add_u32 s25, s25, s29
  s_and_b32 s26, s28, 7
  v_lshlrev_b32 v2, 4, v1
  s_add_u32 s8, s84, 12582912
  s_addc_u32 s9, s85, 0
  s_and_b32 s9, s9, 0xffff
  s_mov_b32 s10, 7340032
  s_mov_b32 s11, 0x20000
  s_and_b32 s29, s24, 3
  s_and_b32 s30, s29, 1
  s_lshr_b32 s31, s29, 1
  s_lshl_b32 s32, s25, 1
  s_add_u32 s32, s32, s31
  s_mul_i32 s32, s32, 112
  s_lshl_b32 s33, s30, 1
  s_add_u32 s32, s32, s33
  s_lshl_b32 s32, s32, 10
  s_lshl_b32 s33, s31, 12
  s_lshl_b32 s34, s30, 11
  s_add_u32 s33, s33, s34
  s_mov_b32 s12, s76
  s_and_b32 s13, s77, 0xffff
  s_mov_b32 s14, 1835008
  s_mov_b32 s15, 0x20000
  v_lshrrev_b32 v23, 3, v1
  s_mov_b32 s59, 1024
  v_mul_lo_u32 v3, v23, s59
  v_bfe_u32 v23, v1, 4, 1
  v_lshlrev_b32 v23, 2, v23
  v_and_b32 v24, 7, v1
  v_xor_b32 v23, v23, v24
  v_lshl_add_u32 v3, v23, 4, v3
  v_add_u32 v13, 7168, v3
  s_lshl_b32 s34, s29, 14
  s_lshl_b32 s35, s26, 7
  s_add_u32 s34, s34, s35
  s_lshl_b32 s35, s29, 11
  s_cmp_ge_u32 s24, 4
  s_cbranch_scc1 P5_prod
  s_add_u32 s16, s84, 10485760
  s_addc_u32 s17, s85, 0
  s_and_b32 s17, s17, 0xffff
  s_mov_b32 s18, 2097152
  s_mov_b32 s19, 0x20000
  s_mov_b32 s20, s78
  s_and_b32 s21, s79, 0xffff
  s_mov_b32 s22, 1024
  s_mov_b32 s23, 0x20000
  s_mov_b32 s52, s80
  s_and_b32 s53, s81, 0xffff
  s_mov_b32 s54, 2097152
  s_mov_b32 s55, 0x20000
  v_and_b32 v12, 31, v1
  v_lshrrev_b32 v14, 5, v1
  s_lshl_b32 s38, s25, 1
  s_add_u32 s38, s38, s30
  s_lshl_b32 s39, s26, 1
  s_add_u32 s39, s39, s31
  v_lshlrev_b32 v15, 10, v12
  v_lshl_add_u32 v15, v14, 4, v15
  s_lshl_b32 s40, s38, 15
  s_lshl_b32 s41, s39, 6
  s_add_u32 s40, s40, s41
  s_lshl_b32 s41, s38, 5
  s_lshl_b32 s42, s39, 1
  s_add_u32 s41, s41, s42
  s_lshl_b32 s41, s41, 10
  v_lshlrev_b32 v16, 4, v14
  s_lshl_b32 s42, s39, 6
  buffer_load_dwordx4 v[104:107], v16, s[20:23], s42 offen
  buffer_load_dwordx4 v[108:111], v16, s[20:23], s42 offen offset:32
  s_lshl_b32 s37, s30, 12
  v_add_u32 v4, s37, v2
  v_bfe_u32 v20, v1, 2, 2
  v_lshrrev_b32 v21, 5, v1
  v_lshl_add_u32 v21, v21, 3, v20
  v_lshlrev_b32 v8, 7, v21
  v_bfe_u32 v21, v1, 4, 1
  v_and_b32 v22, 1, v1
  v_lshl_add_u32 v21, v21, 1, v22
  s_lshl_b32 s59, s31, 2
  v_add_u32 v21, s59, v21
  v_lshrrev_b32 v20, 1, v20
  v_lshlrev_b32 v20, 2, v20
  v_xor_b32 v21, v21, v20
  v_lshl_add_u32 v8, v21, 4, v8
  v_bfe_u32 v22, v1, 1, 1
  v_lshl_add_u32 v8, v22, 3, v8
  v_add_u32 v5, 65536, v4
  v_add_u32 v9, 65536, v8
  v_add_u32 v6, 131072, v4
  v_add_u32 v10, 131072, v8
  v_mov_b32 v32, 0
  v_mov_b32 v33, 0
  v_mov_b32 v34, 0
  v_mov_b32 v35, 0
  v_mov_b32 v36, 0
  v_mov_b32 v37, 0
  v_mov_b32 v38, 0
  v_mov_b32 v39, 0
  v_mov_b32 v40, 0
  v_mov_b32 v41, 0
  v_mov_b32 v42, 0
  v_mov_b32 v43, 0
  v_mov_b32 v44, 0
  v_mov_b32 v45, 0
  v_mov_b32 v46, 0
  v_mov_b32 v47, 0
  s_cmp_lg_u32 s24, 0
  s_cbranch_scc1 P5np_L_15
  s_lshr_b32 s43, s25, 1
  s_lshl_b32 s43, s43, 4
  s_add_u32 s48, s84, 23068672
  s_addc_u32 s49, s85, 0
  s_and_b32 s49, s49, 0xffff
  s_mov_b32 s50, 135168
  s_mov_b32 s51, 0x20000
  s_add_u32 s46, s43, 768
  s_lshl_b32 s46, s46, 7
  v_lshlrev_b32 v250, 7, v1
  s_mov_b32 s47, 100000
  s_mov_b64 exec, 0x3fff
  s_waitcnt vmcnt(0)
  buffer_load_dword v251, v250, s[48:51], s46 offen sc1
  s_sleep 4
P5_poll_L_16:
  buffer_load_dword v253, v250, s[48:51], s46 offen sc1
  s_waitcnt vmcnt(1)
  v_cmp_ne_u32 vcc, s86, v251
  s_nop 4
  s_and_b64 exec, exec, vcc
  s_cbranch_execz P5_poll_L_16_ok
  buffer_load_dword v251, v250, s[48:51], s46 offen sc1
  s_waitcnt vmcnt(1)
  v_cmp_ne_u32 vcc, s86, v253
  s_nop 4
  s_and_b64 exec, exec, vcc
  s_cbranch_execz P5_poll_L_16_ok
  s_sub_u32 s47, s47, 1
  s_cmp_eq_u32 s47, 0
  s_cbranch_scc0 P5_poll_L_16
P5_poll_L_16_ok:
  s_mov_b64 exec, -1
P5np_L_15:
  s_barrier
  s_add_u32 m0, s33, 90112
  s_add_u32 s36, s32, 4096
  buffer_load_dwordx4 v2, s[8:11], s36 offen sc1 lds
  buffer_load_dwordx4 v2, s[8:11], s36 offen offset:1024 sc1 lds
  s_add_u32 m0, s33, 106496
  s_add_u32 s36, s32, 12288
  buffer_load_dwordx4 v2, s[8:11], s36 offen sc1 lds
  buffer_load_dwordx4 v2, s[8:11], s36 offen offset:1024 sc1 lds
  s_waitcnt vmcnt(2)
  s_barrier
  ds_read_b128 v[112:115], v5 offset:16384
  ds_read_b64_tr_b16 v[116:117], v8 offset:0
  ds_read_b64_tr_b16 v[118:119], v8 offset:512
  ds_read_b128 v[120:123], v5 offset:17408
  ds_read_b64_tr_b16 v[124:125], v8 offset:2048
  ds_read_b64_tr_b16 v[126:127], v8 offset:2560
  ds_read_b128 v[128:131], v5 offset:18432
  ds_read_b64_tr_b16 v[132:133], v8 offset:4096
  ds_read_b64_tr_b16 v[134:135], v8 offset:4608
  ds_read_b128 v[136:139], v5 offset:19456
  ds_read_b64_tr_b16 v[140:141], v8 offset:6144
  ds_read_b64_tr_b16 v[142:143], v8 offset:6656
  ds_read_b128 v[144:147], v5 offset:24576
  ds_read_b64_tr_b16 v[148:149], v8 offset:8192
  ds_read_b64_tr_b16 v[150:151], v8 offset:8704
  ds_read_b128 v[152:155], v5 offset:25600
  ds_read_b64_tr_b16 v[156:157], v8 offset:10240
  ds_read_b64_tr_b16 v[158:159], v8 offset:10752
  ds_read_b128 v[160:163], v5 offset:26624
  ds_read_b64_tr_b16 v[164:165], v8 offset:12288
  ds_read_b64_tr_b16 v[166:167], v8 offset:12800
  ds_read_b128 v[168:171], v5 offset:27648
  ds_read_b64_tr_b16 v[172:173], v8 offset:14336
  ds_read_b64_tr_b16 v[174:175], v8 offset:14848
  s_waitcnt vmcnt(0)
  s_barrier
  s_waitcnt lgkmcnt(0)
  v_mfma_f32_32x32x16_bf16 v[32:47], v[116:119], v[112:115], v[32:47]
  ds_read_b128 v[176:179], v5 offset:32768
  ds_read_b64_tr_b16 v[180:181], v8 offset:16384
  ds_read_b64_tr_b16 v[182:183], v8 offset:16896
  ds_read_b128 v[184:187], v5 offset:33792
  v_mfma_f32_32x32x16_bf16 v[32:47], v[124:127], v[120:123], v[32:47]
  ds_read_b64_tr_b16 v[188:189], v8 offset:18432
  ds_read_b64_tr_b16 v[190:191], v8 offset:18944
  ds_read_b128 v[192:195], v5 offset:34816
  ds_read_b64_tr_b16 v[196:197], v8 offset:20480
  v_mfma_f32_32x32x16_bf16 v[32:47], v[132:135], v[128:131], v[32:47]
  ds_read_b64_tr_b16 v[198:199], v8 offset:20992
  ds_read_b128 v[200:203], v5 offset:35840
  ds_read_b64_tr_b16 v[204:205], v8 offset:22528
  ds_read_b64_tr_b16 v[206:207], v8 offset:23040
  v_mfma_f32_32x32x16_bf16 v[32:47], v[140:143], v[136:139], v[32:47]
  ds_read_b128 v[208:211], v5 offset:40960
  ds_read_b64_tr_b16 v[212:213], v8 offset:24576
  ds_read_b64_tr_b16 v[214:215], v8 offset:25088
  ds_read_b128 v[216:219], v5 offset:41984
  v_mfma_f32_32x32x16_bf16 v[32:47], v[148:151], v[144:147], v[32:47]
  ds_read_b64_tr_b16 v[220:221], v8 offset:26624
  ds_read_b64_tr_b16 v[222:223], v8 offset:27136
  ds_read_b128 v[224:227], v5 offset:43008
  ds_read_b64_tr_b16 v[228:229], v8 offset:28672
  v_mfma_f32_32x32x16_bf16 v[32:47], v[156:159], v[152:155], v[32:47]
  ds_read_b64_tr_b16 v[230:231], v8 offset:29184
  ds_read_b128 v[232:235], v5 offset:44032
  ds_read_b64_tr_b16 v[236:237], v8 offset:30720
  ds_read_b64_tr_b16 v[238:239], v8 offset:31232
  v_mfma_f32_32x32x16_bf16 v[32:47], v[164:167], v[160:163], v[32:47]
  v_mfma_f32_32x32x16_bf16 v[32:47], v[172:175], v[168:171], v[32:47]
  s_barrier
  s_waitcnt lgkmcnt(0)
  v_mfma_f32_32x32x16_bf16 v[32:47], v[180:183], v[176:179], v[32:47]
  ds_read_b128 v[112:115], v5 offset:49152
  ds_read_b64_tr_b16 v[116:117], v8 offset:32768
  ds_read_b64_tr_b16 v[118:119], v8 offset:33280
  ds_read_b128 v[120:123], v5 offset:50176
  v_mfma_f32_32x32x16_bf16 v[32:47], v[188:191], v[184:187], v[32:47]
  ds_read_b64_tr_b16 v[124:125], v8 offset:34816
  ds_read_b64_tr_b16 v[126:127], v8 offset:35328
  ds_read_b128 v[128:131], v5 offset:51200
  ds_read_b64_tr_b16 v[132:133], v8 offset:36864
  v_mfma_f32_32x32x16_bf16 v[32:47], v[196:199], v[192:195], v[32:47]
  ds_read_b64_tr_b16 v[134:135], v8 offset:37376
  ds_read_b128 v[136:139], v5 offset:52224
  ds_read_b64_tr_b16 v[140:141], v8 offset:38912
  ds_read_b64_tr_b16 v[142:143], v8 offset:39424
  v_mfma_f32_32x32x16_bf16 v[32:47], v[204:207], v[200:203], v[32:47]
  ds_read_b128 v[144:147], v5 offset:57344
  ds_read_b64_tr_b16 v[148:149], v8 offset:40960
  ds_read_b64_tr_b16 v[150:151], v8 offset:41472
  ds_read_b128 v[152:155], v5 offset:58368
  v_mfma_f32_32x32x16_bf16 v[32:47], v[212:215], v[208:211], v[32:47]
  ds_read_b64_tr_b16 v[156:157], v8 offset:43008
  ds_read_b64_tr_b16 v[158:159], v8 offset:43520
  ds_read_b128 v[160:163], v5 offset:59392
  ds_read_b64_tr_b16 v[164:165], v8 offset:45056
  v_mfma_f32_32x32x16_bf16 v[32:47], v[220:223], v[216:219], v[32:47]
  ds_read_b64_tr_b16 v[166:167], v8 offset:45568
  ds_read_b128 v[168:171], v5 offset:60416
  ds_read_b64_tr_b16 v[172:173], v8 offset:47104
  ds_read_b64_tr_b16 v[174:175], v8 offset:47616
  v_mfma_f32_32x32x16_bf16 v[32:47], v[228:231], v[224:227], v[32:47]
  v_mfma_f32_32x32x16_bf16 v[32:47], v[236:239], v[232:235], v[32:47]
  s_add_u32 m0, s35, 8192
  s_add_u32 s36, s34, 720896
  buffer_load_dwordx4 v3, s[12:15], s36 offen lds
  buffer_load_dwordx4 v13, s[12:15], s36 offen offset:1024 lds
  s_barrier
  s_waitcnt lgkmcnt(0)
  v_mfma_f32_32x32x16_bf16 v[32:47], v[116:119], v[112:115], v[32:47]
  ds_read_b128 v[176:179], v6 offset:0
  ds_read_b64_tr_b16 v[180:181], v8 offset:49152
  ds_read_b64_tr_b16 v[182:183], v8 offset:49664
  ds_read_b128 v[184:187], v6 offset:1024
  v_mfma_f32_32x32x16_bf16 v[32:47], v[124:127], v[120:123], v[32:47]
  ds_read_b64_tr_b16 v[188:189], v8 offset:51200
  ds_read_b64_tr_b16 v[190:191], v8 offset:51712
  ds_read_b128 v[192:195], v6 offset:2048
  ds_read_b64_tr_b16 v[196:197], v8 offset:53248
  v_mfma_f32_32x32x16_bf16 v[32:47], v[132:135], v[128:131], v[32:47]
  ds_read_b64_tr_b16 v[198:199], v8 offset:53760
  ds_read_b128 v[200:203], v6 offset:3072
  ds_read_b64_tr_b16 v[204:205], v8 offset:55296
  ds_read_b64_tr_b16 v[206:207], v8 offset:55808
  v_mfma_f32_32x32x16_bf16 v[32:47], v[140:143], v[136:139], v[32:47]
  ds_read_b128 v[208:211], v6 offset:8192
  ds_read_b64_tr_b16 v[212:213], v8 offset:57344
  ds_read_b64_tr_b16 v[214:215], v8 offset:57856
  ds_read_b128 v[216:219], v6 offset:9216
  v_mfma_f32_32x32x16_bf16 v[32:47], v[148:151], v[144:147], v[32:47]
  ds_read_b64_tr_b16 v[220:221], v8 offset:59392
  ds_read_b64_tr_b16 v[222:223], v8 offset:59904
  ds_read_b128 v[224:227], v6 offset:10240
  ds_read_b64_tr_b16 v[228:229], v8 offset:61440
  v_mfma_f32_32x32x16_bf16 v[32:47], v[156:159], v[152:155], v[32:47]
  ds_read_b64_tr_b16 v[230:231], v8 offset:61952
  ds_read_b128 v[232:235], v6 offset:11264
  ds_read_b64_tr_b16 v[236:237], v8 offset:63488
  ds_read_b64_tr_b16 v[238:239], v8 offset:64000
  v_mfma_f32_32x32x16_bf16 v[32:47], v[164:167], v[160:163], v[32:47]
  v_mfma_f32_32x32x16_bf16 v[32:47], v[172:175], v[168:171], v[32:47]
  s_add_u32 m0, s35, 24576
  s_add_u32 s36, s34, 851968
  buffer_load_dwordx4 v3, s[12:15], s36 offen lds
  buffer_load_dwordx4 v13, s[12:15], s36 offen offset:1024 lds
  s_barrier
  s_waitcnt lgkmcnt(0)
  v_mfma_f32_32x32x16_bf16 v[32:47], v[180:183], v[176:179], v[32:47]
  ds_read_b128 v[112:115], v6 offset:16384
  ds_read_b64_tr_b16 v[116:117], v9 offset:0
  ds_read_b64_tr_b16 v[118:119], v9 offset:512
  ds_read_b128 v[120:123], v6 offset:17408
  v_mfma_f32_32x32x16_bf16 v[32:47], v[188:191], v[184:187], v[32:47]
  ds_read_b64_tr_b16 v[124:125], v9 offset:2048
  ds_read_b64_tr_b16 v[126:127], v9 offset:2560
  ds_read_b128 v[128:131], v6 offset:18432
  ds_read_b64_tr_b16 v[132:133], v9 offset:4096
  v_mfma_f32_32x32x16_bf16 v[32:47], v[196:199], v[192:195], v[32:47]
  ds_read_b64_tr_b16 v[134:135], v9 offset:4608
  ds_read_b128 v[136:139], v6 offset:19456
  ds_read_b64_tr_b16 v[140:141], v9 offset:6144
  ds_read_b64_tr_b16 v[142:143], v9 offset:6656
  v_mfma_f32_32x32x16_bf16 v[32:47], v[204:207], v[200:203], v[32:47]
  ds_read_b128 v[144:147], v5 offset:16384
  ds_read_b64_tr_b16 v[148:149], v9 offset:8192
  ds_read_b64_tr_b16 v[150:151], v9 offset:8704
  ds_read_b128 v[152:155], v5 offset:17408
  v_mfma_f32_32x32x16_bf16 v[32:47], v[212:215], v[208:211], v[32:47]
  ds_read_b64_tr_b16 v[156:157], v9 offset:10240
  ds_read_b64_tr_b16 v[158:159], v9 offset:10752
  ds_read_b128 v[160:163], v5 offset:18432
  ds_read_b64_tr_b16 v[164:165], v9 offset:12288
  v_mfma_f32_32x32x16_bf16 v[32:47], v[220:223], v[216:219], v[32:47]
  ds_read_b64_tr_b16 v[166:167], v9 offset:12800
  ds_read_b128 v[168:171], v5 offset:19456
  ds_read_b64_tr_b16 v[172:173], v9 offset:14336
  ds_read_b64_tr_b16 v[174:175], v9 offset:14848
  v_mfma_f32_32x32x16_bf16 v[32:47], v[228:231], v[224:227], v[32:47]
  v_mfma_f32_32x32x16_bf16 v[32:47], v[236:239], v[232:235], v[32:47]
  s_add_u32 m0, s35, 40960
  s_add_u32 s36, s34, 983040
  buffer_load_dwordx4 v3, s[12:15], s36 offen lds
  buffer_load_dwordx4 v13, s[12:15], s36 offen offset:1024 lds
  s_waitcnt vmcnt(4)
  s_barrier
  s_waitcnt lgkmcnt(0)
  v_mfma_f32_32x32x16_bf16 v[32:47], v[116:119], v[112:115], v[32:47]
  ds_read_b128 v[176:179], v5 offset:24576
  ds_read_b64_tr_b16 v[180:181], v8 offset:0
  ds_read_b64_tr_b16 v[182:183], v8 offset:512
  ds_read_b128 v[184:187], v5 offset:25600
  v_mfma_f32_32x32x16_bf16 v[32:47], v[124:127], v[120:123], v[32:47]
  ds_read_b64_tr_b16 v[188:189], v8 offset:2048
  ds_read_b64_tr_b16 v[190:191], v8 offset:2560
  ds_read_b128 v[192:195], v5 offset:26624
  ds_read_b64_tr_b16 v[196:197], v8 offset:4096
  v_mfma_f32_32x32x16_bf16 v[32:47], v[132:135], v[128:131], v[32:47]
  ds_read_b64_tr_b16 v[198:199], v8 offset:4608
  ds_read_b128 v[200:203], v5 offset:27648
  ds_read_b64_tr_b16 v[204:205], v8 offset:6144
  ds_read_b64_tr_b16 v[206:207], v8 offset:6656
  v_mfma_f32_32x32x16_bf16 v[32:47], v[140:143], v[136:139], v[32:47]
  ds_read_b128 v[208:211], v5 offset:32768
  ds_read_b64_tr_b16 v[212:213], v8 offset:8192
  ds_read_b64_tr_b16 v[214:215], v8 offset:8704
  ds_read_b128 v[216:219], v5 offset:33792
  v_mfma_f32_32x32x16_bf16 v[32:47], v[148:151], v[144:147], v[32:47]
  ds_read_b64_tr_b16 v[220:221], v8 offset:10240
  ds_read_b64_tr_b16 v[222:223], v8 offset:10752
  ds_read_b128 v[224:227], v5 offset:34816
  ds_read_b64_tr_b16 v[228:229], v8 offset:12288
  v_mfma_f32_32x32x16_bf16 v[32:47], v[156:159], v[152:155], v[32:47]
  ds_read_b64_tr_b16 v[230:231], v8 offset:12800
  ds_read_b128 v[232:235], v5 offset:35840
  ds_read_b64_tr_b16 v[236:237], v8 offset:14336
  ds_read_b64_tr_b16 v[238:239], v8 offset:14848
  v_mfma_f32_32x32x16_bf16 v[32:47], v[164:167], v[160:163], v[32:47]
  v_mfma_f32_32x32x16_bf16 v[32:47], v[172:175], v[168:171], v[32:47]
  s_add_u32 m0, s35, 57344
  s_add_u32 s36, s34, 1114112
  buffer_load_dwordx4 v3, s[12:15], s36 offen lds
  buffer_load_dwordx4 v13, s[12:15], s36 offen offset:1024 lds
  s_waitcnt vmcnt(4)
  s_barrier
  s_waitcnt lgkmcnt(0)
  v_mfma_f32_32x32x16_bf16 v[32:47], v[180:183], v[176:179], v[32:47]
  ds_read_b128 v[112:115], v5 offset:40960
  ds_read_b64_tr_b16 v[116:117], v8 offset:16384
  ds_read_b64_tr_b16 v[118:119], v8 offset:16896
  ds_read_b128 v[120:123], v5 offset:41984
  v_mfma_f32_32x32x16_bf16 v[32:47], v[188:191], v[184:187], v[32:47]
  ds_read_b64_tr_b16 v[124:125], v8 offset:18432
  ds_read_b64_tr_b16 v[126:127], v8 offset:18944
  ds_read_b128 v[128:131], v5 offset:43008
  ds_read_b64_tr_b16 v[132:133], v8 offset:20480
  v_mfma_f32_32x32x16_bf16 v[32:47], v[196:199], v[192:195], v[32:47]
  ds_read_b64_tr_b16 v[134:135], v8 offset:20992
  ds_read_b128 v[136:139], v5 offset:44032
  ds_read_b64_tr_b16 v[140:141], v8 offset:22528
  ds_read_b64_tr_b16 v[142:143], v8 offset:23040
  v_mfma_f32_32x32x16_bf16 v[32:47], v[204:207], v[200:203], v[32:47]
  ds_read_b128 v[144:147], v5 offset:49152
  ds_read_b64_tr_b16 v[148:149], v8 offset:24576
  ds_read_b64_tr_b16 v[150:151], v8 offset:25088
  ds_read_b128 v[152:155], v5 offset:50176
  v_mfma_f32_32x32x16_bf16 v[32:47], v[212:215], v[208:211], v[32:47]
  ds_read_b64_tr_b16 v[156:157], v8 offset:26624
  ds_read_b64_tr_b16 v[158:159], v8 offset:27136
  ds_read_b128 v[160:163], v5 offset:51200
  ds_read_b64_tr_b16 v[164:165], v8 offset:28672
  v_mfma_f32_32x32x16_bf16 v[32:47], v[220:223], v[216:219], v[32:47]
  ds_read_b64_tr_b16 v[166:167], v8 offset:29184
  ds_read_b128 v[168:171], v5 offset:52224
  ds_read_b64_tr_b16 v[172:173], v8 offset:30720
  ds_read_b64_tr_b16 v[174:175], v8 offset:31232
  v_mfma_f32_32x32x16_bf16 v[32:47], v[228:231], v[224:227], v[32:47]
  v_mfma_f32_32x32x16_bf16 v[32:47], v[236:239], v[232:235], v[32:47]
  s_add_u32 m0, s35, 73728
  s_add_u32 s36, s34, 1245184
  buffer_load_dwordx4 v3, s[12:15], s36 offen lds
  buffer_load_dwordx4 v13, s[12:15], s36 offen offset:1024 lds
  s_waitcnt vmcnt(4)
  s_barrier
  s_waitcnt lgkmcnt(0)
  v_mfma_f32_32x32x16_bf16 v[32:47], v[116:119], v[112:115], v[32:47]
  ds_read_b128 v[176:179], v5 offset:57344
  ds_read_b64_tr_b16 v[180:181], v8 offset:32768
  ds_read_b64_tr_b16 v[182:183], v8 offset:33280
  ds_read_b128 v[184:187], v5 offset:58368
  v_mfma_f32_32x32x16_bf16 v[32:47], v[124:127], v[120:123], v[32:47]
  ds_read_b64_tr_b16 v[188:189], v8 offset:34816
  ds_read_b64_tr_b16 v[190:191], v8 offset:35328
  ds_read_b128 v[192:195], v5 offset:59392
  ds_read_b64_tr_b16 v[196:197], v8 offset:36864
  v_mfma_f32_32x32x16_bf16 v[32:47], v[132:135], v[128:131], v[32:47]
  ds_read_b64_tr_b16 v[198:199], v8 offset:37376
  ds_read_b128 v[200:203], v5 offset:60416
  ds_read_b64_tr_b16 v[204:205], v8 offset:38912
  ds_read_b64_tr_b16 v[206:207], v8 offset:39424
  v_mfma_f32_32x32x16_bf16 v[32:47], v[140:143], v[136:139], v[32:47]
  ds_read_b128 v[208:211], v6 offset:0
  ds_read_b64_tr_b16 v[212:213], v8 offset:40960
  ds_read_b64_tr_b16 v[214:215], v8 offset:41472
  ds_read_b128 v[216:219], v6 offset:1024
  v_mfma_f32_32x32x16_bf16 v[32:47], v[148:151], v[144:147], v[32:47]
  ds_read_b64_tr_b16 v[220:221], v8 offset:43008
  ds_read_b64_tr_b16 v[222:223], v8 offset:43520
  ds_read_b128 v[224:227], v6 offset:2048
  ds_read_b64_tr_b16 v[228:229], v8 offset:45056
  v_mfma_f32_32x32x16_bf16 v[32:47], v[156:159], v[152:155], v[32:47]
  ds_read_b64_tr_b16 v[230:231], v8 offset:45568
  ds_read_b128 v[232:235], v6 offset:3072
  ds_read_b64_tr_b16 v[236:237], v8 offset:47104
  ds_read_b64_tr_b16 v[238:239], v8 offset:47616
  v_mfma_f32_32x32x16_bf16 v[32:47], v[164:167], v[160:163], v[32:47]
  v_mfma_f32_32x32x16_bf16 v[32:47], v[172:175], v[168:171], v[32:47]
  s_add_u32 m0, s35, 8192
  s_add_u32 s36, s34, 1376256
  buffer_load_dwordx4 v3, s[12:15], s36 offen lds
  buffer_load_dwordx4 v13, s[12:15], s36 offen offset:1024 lds
  s_waitcnt vmcnt(4)
  s_barrier
  s_waitcnt lgkmcnt(0)
  v_mfma_f32_32x32x16_bf16 v[32:47], v[180:183], v[176:179], v[32:47]
  ds_read_b128 v[112:115], v6 offset:8192
  ds_read_b64_tr_b16 v[116:117], v8 offset:49152
  ds_read_b64_tr_b16 v[118:119], v8 offset:49664
  ds_read_b128 v[120:123], v6 offset:9216
  v_mfma_f32_32x32x16_bf16 v[32:47], v[188:191], v[184:187], v[32:47]
  ds_read_b64_tr_b16 v[124:125], v8 offset:51200
  ds_read_b64_tr_b16 v[126:127], v8 offset:51712
  ds_read_b128 v[128:131], v6 offset:10240
  ds_read_b64_tr_b16 v[132:133], v8 offset:53248
  v_mfma_f32_32x32x16_bf16 v[32:47], v[196:199], v[192:195], v[32:47]
  ds_read_b64_tr_b16 v[134:135], v8 offset:53760
  ds_read_b128 v[136:139], v6 offset:11264
  ds_read_b64_tr_b16 v[140:141], v8 offset:55296
  ds_read_b64_tr_b16 v[142:143], v8 offset:55808
  v_mfma_f32_32x32x16_bf16 v[32:47], v[204:207], v[200:203], v[32:47]
  ds_read_b128 v[144:147], v6 offset:16384
  ds_read_b64_tr_b16 v[148:149], v8 offset:57344
  ds_read_b64_tr_b16 v[150:151], v8 offset:57856
  ds_read_b128 v[152:155], v6 offset:17408
  v_mfma_f32_32x32x16_bf16 v[32:47], v[212:215], v[208:211], v[32:47]
  ds_read_b64_tr_b16 v[156:157], v8 offset:59392
  ds_read_b64_tr_b16 v[158:159], v8 offset:59904
  ds_read_b128 v[160:163], v6 offset:18432
  ds_read_b64_tr_b16 v[164:165], v8 offset:61440
  v_mfma_f32_32x32x16_bf16 v[32:47], v[220:223], v[216:219], v[32:47]
  ds_read_b64_tr_b16 v[166:167], v8 offset:61952
  ds_read_b128 v[168:171], v6 offset:19456
  ds_read_b64_tr_b16 v[172:173], v8 offset:63488
  ds_read_b64_tr_b16 v[174:175], v8 offset:64000
  v_mfma_f32_32x32x16_bf16 v[32:47], v[228:231], v[224:227], v[32:47]
  v_mfma_f32_32x32x16_bf16 v[32:47], v[236:239], v[232:235], v[32:47]
  s_add_u32 m0, s35, 24576
  s_add_u32 s36, s34, 1507328
  buffer_load_dwordx4 v3, s[12:15], s36 offen lds
  buffer_load_dwordx4 v13, s[12:15], s36 offen offset:1024 lds
  s_waitcnt vmcnt(4)
  s_barrier
  s_waitcnt lgkmcnt(0)
  v_mfma_f32_32x32x16_bf16 v[32:47], v[116:119], v[112:115], v[32:47]
  ds_read_b128 v[176:179], v5 offset:16384
  ds_read_b64_tr_b16 v[180:181], v9 offset:0
  ds_read_b64_tr_b16 v[182:183], v9 offset:512
  ds_read_b128 v[184:187], v5 offset:17408
  v_mfma_f32_32x32x16_bf16 v[32:47], v[124:127], v[120:123], v[32:47]
  ds_read_b64_tr_b16 v[188:189], v9 offset:2048
  ds_read_b64_tr_b16 v[190:191], v9 offset:2560
  ds_read_b128 v[192:195], v5 offset:18432
  ds_read_b64_tr_b16 v[196:197], v9 offset:4096
  v_mfma_f32_32x32x16_bf16 v[32:47], v[132:135], v[128:131], v[32:47]
  ds_read_b64_tr_b16 v[198:199], v9 offset:4608
  ds_read_b128 v[200:203], v5 offset:19456
  ds_read_b64_tr_b16 v[204:205], v9 offset:6144
  ds_read_b64_tr_b16 v[206:207], v9 offset:6656
  v_mfma_f32_32x32x16_bf16 v[32:47], v[140:143], v[136:139], v[32:47]
  ds_read_b128 v[208:211], v5 offset:24576
  ds_read_b64_tr_b16 v[212:213], v9 offset:8192
  ds_read_b64_tr_b16 v[214:215], v9 offset:8704
  ds_read_b128 v[216:219], v5 offset:25600
  v_mfma_f32_32x32x16_bf16 v[32:47], v[148:151], v[144:147], v[32:47]
  ds_read_b64_tr_b16 v[220:221], v9 offset:10240
  ds_read_b64_tr_b16 v[222:223], v9 offset:10752
  ds_read_b128 v[224:227], v5 offset:26624
  ds_read_b64_tr_b16 v[228:229], v9 offset:12288
  v_mfma_f32_32x32x16_bf16 v[32:47], v[156:159], v[152:155], v[32:47]
  ds_read_b64_tr_b16 v[230:231], v9 offset:12800
  ds_read_b128 v[232:235], v5 offset:27648
  ds_read_b64_tr_b16 v[236:237], v9 offset:14336
  ds_read_b64_tr_b16 v[238:239], v9 offset:14848
  v_mfma_f32_32x32x16_bf16 v[32:47], v[164:167], v[160:163], v[32:47]
  v_mfma_f32_32x32x16_bf16 v[32:47], v[172:175], v[168:171], v[32:47]
  s_add_u32 m0, s35, 40960
  s_add_u32 s36, s34, 1638400
  buffer_load_dwordx4 v3, s[12:15], s36 offen lds
  buffer_load_dwordx4 v13, s[12:15], s36 offen offset:1024 lds
  s_waitcnt vmcnt(4)
  s_barrier
  s_waitcnt lgkmcnt(0)
  v_mfma_f32_32x32x16_bf16 v[32:47], v[180:183], v[176:179], v[32:47]
  ds_read_b128 v[112:115], v5 offset:32768
  ds_read_b64_tr_b16 v[116:117], v8 offset:0
  ds_read_b64_tr_b16 v[118:119], v8 offset:512
  ds_read_b128 v[120:123], v5 offset:33792
  v_mfma_f32_32x32x16_bf16 v[32:47], v[188:191], v[184:187], v[32:47]
  ds_read_b64_tr_b16 v[124:125], v8 offset:2048
  ds_read_b64_tr_b16 v[126:127], v8 offset:2560
  ds_read_b128 v[128:131], v5 offset:34816
  ds_read_b64_tr_b16 v[132:133], v8 offset:4096
  v_mfma_f32_32x32x16_bf16 v[32:47], v[196:199], v[192:195], v[32:47]
  ds_read_b64_tr_b16 v[134:135], v8 offset:4608
  ds_read_b128 v[136:139], v5 offset:35840
  ds_read_b64_tr_b16 v[140:141], v8 offset:6144
  ds_read_b64_tr_b16 v[142:143], v8 offset:6656
  v_mfma_f32_32x32x16_bf16 v[32:47], v[204:207], v[200:203], v[32:47]
  ds_read_b128 v[144:147], v5 offset:40960
  ds_read_b64_tr_b16 v[148:149], v8 offset:8192
  ds_read_b64_tr_b16 v[150:151], v8 offset:8704
  ds_read_b128 v[152:155], v5 offset:41984
  v_mfma_f32_32x32x16_bf16 v[32:47], v[212:215], v[208:211], v[32:47]
  ds_read_b64_tr_b16 v[156:157], v8 offset:10240
  ds_read_b64_tr_b16 v[158:159], v8 offset:10752
  ds_read_b128 v[160:163], v5 offset:43008
  ds_read_b64_tr_b16 v[164:165], v8 offset:12288
  v_mfma_f32_32x32x16_bf16 v[32:47], v[220:223], v[216:219], v[32:47]
  ds_read_b64_tr_b16 v[166:167], v8 offset:12800
  ds_read_b128 v[168:171], v5 offset:44032
  ds_read_b64_tr_b16 v[172:173], v8 offset:14336
  ds_read_b64_tr_b16 v[174:175], v8 offset:14848
  v_mfma_f32_32x32x16_bf16 v[32:47], v[228:231], v[224:227], v[32:47]
  v_mfma_f32_32x32x16_bf16 v[32:47], v[236:239], v[232:235], v[32:47]
  s_add_u32 m0, s35, 57344
  s_add_u32 s36, s34, 1769472
  buffer_load_dwordx4 v3, s[12:15], s36 offen lds
  buffer_load_dwordx4 v13, s[12:15], s36 offen offset:1024 lds
  s_waitcnt vmcnt(4)
  s_barrier
  s_waitcnt lgkmcnt(0)
  v_mfma_f32_32x32x16_bf16 v[32:47], v[116:119], v[112:115], v[32:47]
  ds_read_b128 v[176:179], v5 offset:49152
  ds_read_b64_tr_b16 v[180:181], v8 offset:16384
  ds_read_b64_tr_b16 v[182:183], v8 offset:16896
  ds_read_b128 v[184:187], v5 offset:50176
  v_mfma_f32_32x32x16_bf16 v[32:47], v[124:127], v[120:123], v[32:47]
  ds_read_b64_tr_b16 v[188:189], v8 offset:18432
  ds_read_b64_tr_b16 v[190:191], v8 offset:18944
  ds_read_b128 v[192:195], v5 offset:51200
  ds_read_b64_tr_b16 v[196:197], v8 offset:20480
  v_mfma_f32_32x32x16_bf16 v[32:47], v[132:135], v[128:131], v[32:47]
  ds_read_b64_tr_b16 v[198:199], v8 offset:20992
  ds_read_b128 v[200:203], v5 offset:52224
  ds_read_b64_tr_b16 v[204:205], v8 offset:22528
  ds_read_b64_tr_b16 v[206:207], v8 offset:23040
  v_mfma_f32_32x32x16_bf16 v[32:47], v[140:143], v[136:139], v[32:47]
  ds_read_b128 v[208:211], v5 offset:57344
  ds_read_b64_tr_b16 v[212:213], v8 offset:24576
  ds_read_b64_tr_b16 v[214:215], v8 offset:25088
  ds_read_b128 v[216:219], v5 offset:58368
  v_mfma_f32_32x32x16_bf16 v[32:47], v[148:151], v[144:147], v[32:47]
  ds_read_b64_tr_b16 v[220:221], v8 offset:26624
  ds_read_b64_tr_b16 v[222:223], v8 offset:27136
  ds_read_b128 v[224:227], v5 offset:59392
  ds_read_b64_tr_b16 v[228:229], v8 offset:28672
  v_mfma_f32_32x32x16_bf16 v[32:47], v[156:159], v[152:155], v[32:47]
  ds_read_b64_tr_b16 v[230:231], v8 offset:29184
  ds_read_b128 v[232:235], v5 offset:60416
  ds_read_b64_tr_b16 v[236:237], v8 offset:30720
  ds_read_b64_tr_b16 v[238:239], v8 offset:31232
  v_mfma_f32_32x32x16_bf16 v[32:47], v[164:167], v[160:163], v[32:47]
  v_mfma_f32_32x32x16_bf16 v[32:47], v[172:175], v[168:171], v[32:47]
  s_waitcnt vmcnt(2)
  s_barrier
  s_waitcnt lgkmcnt(0)
  v_mfma_f32_32x32x16_bf16 v[32:47], v[180:183], v[176:179], v[32:47]
  ds_read_b128 v[112:115], v6 offset:0
  ds_read_b64_tr_b16 v[116:117], v8 offset:32768
  ds_read_b64_tr_b16 v[118:119], v8 offset:33280
  ds_read_b128 v[120:123], v6 offset:1024
  v_mfma_f32_32x32x16_bf16 v[32:47], v[188:191], v[184:187], v[32:47]
  ds_read_b64_tr_b16 v[124:125], v8 offset:34816
  ds_read_b64_tr_b16 v[126:127], v8 offset:35328
  ds_read_b128 v[128:131], v6 offset:2048
  ds_read_b64_tr_b16 v[132:133], v8 offset:36864
  v_mfma_f32_32x32x16_bf16 v[32:47], v[196:199], v[192:195], v[32:47]
  ds_read_b64_tr_b16 v[134:135], v8 offset:37376
  ds_read_b128 v[136:139], v6 offset:3072
  ds_read_b64_tr_b16 v[140:141], v8 offset:38912
  ds_read_b64_tr_b16 v[142:143], v8 offset:39424
  v_mfma_f32_32x32x16_bf16 v[32:47], v[204:207], v[200:203], v[32:47]
  ds_read_b128 v[144:147], v6 offset:8192
  ds_read_b64_tr_b16 v[148:149], v8 offset:40960
  ds_read_b64_tr_b16 v[150:151], v8 offset:41472
  ds_read_b128 v[152:155], v6 offset:9216
  v_mfma_f32_32x32x16_bf16 v[32:47], v[212:215], v[208:211], v[32:47]
  ds_read_b64_tr_b16 v[156:157], v8 offset:43008
  ds_read_b64_tr_b16 v[158:159], v8 offset:43520
  ds_read_b128 v[160:163], v6 offset:10240
  ds_read_b64_tr_b16 v[164:165], v8 offset:45056
  v_mfma_f32_32x32x16_bf16 v[32:47], v[220:223], v[216:219], v[32:47]
  ds_read_b64_tr_b16 v[166:167], v8 offset:45568
  ds_read_b128 v[168:171], v6 offset:11264
  ds_read_b64_tr_b16 v[172:173], v8 offset:47104
  ds_read_b64_tr_b16 v[174:175], v8 offset:47616
  v_mfma_f32_32x32x16_bf16 v[32:47], v[228:231], v[224:227], v[32:47]
  v_mfma_f32_32x32x16_bf16 v[32:47], v[236:239], v[232:235], v[32:47]
  s_waitcnt vmcnt(0)
  s_barrier
  s_waitcnt lgkmcnt(0)
  v_mfma_f32_32x32x16_bf16 v[32:47], v[116:119], v[112:115], v[32:47]
  ds_read_b128 v[176:179], v6 offset:16384
  ds_read_b64_tr_b16 v[180:181], v8 offset:49152
  ds_read_b64_tr_b16 v[182:183], v8 offset:49664
  ds_read_b128 v[184:187], v6 offset:17408
  v_mfma_f32_32x32x16_bf16 v[32:47], v[124:127], v[120:123], v[32:47]
  ds_read_b64_tr_b16 v[188:189], v8 offset:51200
  ds_read_b64_tr_b16 v[190:191], v8 offset:51712
  ds_read_b128 v[192:195], v6 offset:18432
  ds_read_b64_tr_b16 v[196:197], v8 offset:53248
  v_mfma_f32_32x32x16_bf16 v[32:47], v[132:135], v[128:131], v[32:47]
  ds_read_b64_tr_b16 v[198:199], v8 offset:53760
  ds_read_b128 v[200:203], v6 offset:19456
  ds_read_b64_tr_b16 v[204:205], v8 offset:55296
  ds_read_b64_tr_b16 v[206:207], v8 offset:55808
  v_mfma_f32_32x32x16_bf16 v[32:47], v[140:143], v[136:139], v[32:47]
  ds_read_b128 v[208:211], v5 offset:16384
  ds_read_b64_tr_b16 v[212:213], v8 offset:57344
  ds_read_b64_tr_b16 v[214:215], v8 offset:57856
  ds_read_b128 v[216:219], v5 offset:17408
  v_mfma_f32_32x32x16_bf16 v[32:47], v[148:151], v[144:147], v[32:47]
  ds_read_b64_tr_b16 v[220:221], v8 offset:59392
  ds_read_b64_tr_b16 v[222:223], v8 offset:59904
  ds_read_b128 v[224:227], v5 offset:18432
  ds_read_b64_tr_b16 v[228:229], v8 offset:61440
  v_mfma_f32_32x32x16_bf16 v[32:47], v[156:159], v[152:155], v[32:47]
  ds_read_b64_tr_b16 v[230:231], v8 offset:61952
  ds_read_b128 v[232:235], v5 offset:19456
  ds_read_b64_tr_b16 v[236:237], v8 offset:63488
  ds_read_b64_tr_b16 v[238:239], v8 offset:64000
  v_mfma_f32_32x32x16_bf16 v[32:47], v[164:167], v[160:163], v[32:47]
  v_mfma_f32_32x32x16_bf16 v[32:47], v[172:175], v[168:171], v[32:47]
  s_waitcnt lgkmcnt(0)
  s_barrier
  v_mfma_f32_32x32x16_bf16 v[32:47], v[180:183], v[176:179], v[32:47]
  v_mfma_f32_32x32x16_bf16 v[32:47], v[188:191], v[184:187], v[32:47]
  v_mfma_f32_32x32x16_bf16 v[32:47], v[196:199], v[192:195], v[32:47]
  v_mfma_f32_32x32x16_bf16 v[32:47], v[204:207], v[200:203], v[32:47]
  v_mfma_f32_32x32x16_bf16 v[32:47], v[212:215], v[208:211], v[32:47]
  v_mfma_f32_32x32x16_bf16 v[32:47], v[220:223], v[216:219], v[32:47]
  v_mfma_f32_32x32x16_bf16 v[32:47], v[228:231], v[224:227], v[32:47]
  v_mfma_f32_32x32x16_bf16 v[32:47], v[236:239], v[232:235], v[32:47]
  s_waitcnt vmcnt(0)
  v_lshlrev_b32 v64, 16, v240
  v_and_b32 v65, 0xffff0000, v240
  v_lshlrev_b32 v66, 16, v241
  v_and_b32 v67, 0xffff0000, v241
  v_lshlrev_b32 v68, 16, v242
  v_and_b32 v69, 0xffff0000, v242
  v_lshlrev_b32 v70, 16, v243
  v_and_b32 v71, 0xffff0000, v243
  v_lshlrev_b32 v72, 16, v244
  v_and_b32 v73, 0xffff0000, v244
  v_lshlrev_b32 v74, 16, v245
  v_and_b32 v75, 0xffff0000, v245
  v_lshlrev_b32 v76, 16, v246
  v_and_b32 v77, 0xffff0000, v246
  v_lshlrev_b32 v78, 16, v247
  v_and_b32 v79, 0xffff0000, v247
  v_lshlrev_b32 v16, 16, v104
  v_and_b32 v17, 0xffff0000, v104
  v_pk_add_f32 v[64:65], v[64:65], v[16:17]
  v_lshlrev_b32 v16, 16, v105
  v_and_b32 v17, 0xffff0000, v105
  v_pk_add_f32 v[66:67], v[66:67], v[16:17]
  v_lshlrev_b32 v16, 16, v106
  v_and_b32 v17, 0xffff0000, v106
  v_pk_add_f32 v[68:69], v[68:69], v[16:17]
  v_lshlrev_b32 v16, 16, v107
  v_and_b32 v17, 0xffff0000, v107
  v_pk_add_f32 v[70:71], v[70:71], v[16:17]
  v_lshlrev_b32 v16, 16, v108
  v_and_b32 v17, 0xffff0000, v108
  v_pk_add_f32 v[72:73], v[72:73], v[16:17]
  v_lshlrev_b32 v16, 16, v109
  v_and_b32 v17, 0xffff0000, v109
  v_pk_add_f32 v[74:75], v[74:75], v[16:17]
  v_lshlrev_b32 v16, 16, v110
  v_and_b32 v17, 0xffff0000, v110
  v_pk_add_f32 v[76:77], v[76:77], v[16:17]
  v_lshlrev_b32 v16, 16, v111
  v_and_b32 v17, 0xffff0000, v111
  v_pk_add_f32 v[78:79], v[78:79], v[16:17]
  v_pk_add_f32 v[32:33], v[32:33], v[64:65]
  v_pk_add_f32 v[34:35], v[34:35], v[66:67]
  v_pk_add_f32 v[36:37], v[36:37], v[68:69]
  v_pk_add_f32 v[38:39], v[38:39], v[70:71]
  v_pk_add_f32 v[40:41], v[40:41], v[72:73]
  v_pk_add_f32 v[42:43], v[42:43], v[74:75]
  v_pk_add_f32 v[44:45], v[44:45], v[76:77]
  v_pk_add_f32 v[46:47], v[46:47], v[78:79]
  v_cvt_pk_bf16_f32 v48, v32, v33
  v_cvt_pk_bf16_f32 v49, v34, v35
  v_cvt_pk_bf16_f32 v50, v36, v37
  v_cvt_pk_bf16_f32 v51, v38, v39
  v_cvt_pk_bf16_f32 v52, v40, v41
  v_cvt_pk_bf16_f32 v53, v42, v43
  v_cvt_pk_bf16_f32 v54, v44, v45
  v_cvt_pk_bf16_f32 v55, v46, v47
  buffer_store_dwordx4 v[48:51], v15, s[52:55], s40 offen
  buffer_store_dwordx4 v[52:55], v15, s[52:55], s40 offen offset:32
  s_branch P5_join
P5_prod:
  s_add_u32 m0, s35, 0
  s_add_u32 s36, s34, 0
  buffer_load_dwordx4 v3, s[12:15], s36 offen lds
  buffer_load_dwordx4 v13, s[12:15], s36 offen offset:1024 lds
  s_add_u32 m0, s35, 8192
  s_add_u32 s36, s34, 65536
  buffer_load_dwordx4 v3, s[12:15], s36 offen lds
  buffer_load_dwordx4 v13, s[12:15], s36 offen offset:1024 lds
  s_add_u32 m0, s35, 16384
  s_add_u32 s36, s34, 131072
  buffer_load_dwordx4 v3, s[12:15], s36 offen lds
  buffer_load_dwordx4 v13, s[12:15], s36 offen offset:1024 lds
  s_add_u32 m0, s35, 24576
  s_add_u32 s36, s34, 196608
  buffer_load_dwordx4 v3, s[12:15], s36 offen lds
  buffer_load_dwordx4 v13, s[12:15], s36 offen offset:1024 lds
  s_add_u32 m0, s35, 32768
  s_add_u32 s36, s34, 262144
  buffer_load_dwordx4 v3, s[12:15], s36 offen lds
  buffer_load_dwordx4 v13, s[12:15], s36 offen offset:1024 lds
  s_add_u32 m0, s35, 40960
  s_add_u32 s36, s34, 327680
  buffer_load_dwordx4 v3, s[12:15], s36 offen lds
  buffer_load_dwordx4 v13, s[12:15], s36 offen offset:1024 lds
  s_add_u32 m0, s35, 49152
  s_add_u32 s36, s34, 393216
  buffer_load_dwordx4 v3, s[12:15], s36 offen lds
  buffer_load_dwordx4 v13, s[12:15], s36 offen offset:1024 lds
  s_add_u32 m0, s35, 57344
  s_add_u32 s36, s34, 458752
  buffer_load_dwordx4 v3, s[12:15], s36 offen lds
  buffer_load_dwordx4 v13, s[12:15], s36 offen offset:1024 lds
  s_add_u32 m0, s35, 65536
  s_add_u32 s36, s34, 524288
  buffer_load_dwordx4 v3, s[12:15], s36 offen lds
  buffer_load_dwordx4 v13, s[12:15], s36 offen offset:1024 lds
  s_add_u32 m0, s35, 73728
  s_add_u32 s36, s34, 589824
  buffer_load_dwordx4 v3, s[12:15], s36 offen lds
  buffer_load_dwordx4 v13, s[12:15], s36 offen offset:1024 lds
  s_barrier
  s_add_u32 m0, s33, 81920
  s_add_u32 s36, s32, 0
  buffer_load_dwordx4 v2, s[8:11], s36 offen sc1 lds
  buffer_load_dwordx4 v2, s[8:11], s36 offen offset:1024 sc1 lds
  s_add_u32 m0, s33, 98304
  s_add_u32 s36, s32, 8192
  buffer_load_dwordx4 v2, s[8:11], s36 offen sc1 lds
  buffer_load_dwordx4 v2, s[8:11], s36 offen offset:1024 sc1 lds
  s_add_u32 m0, s33, 114688
  s_add_u32 s36, s32, 16384
  buffer_load_dwordx4 v2, s[8:11], s36 offen sc1 lds
  buffer_load_dwordx4 v2, s[8:11], s36 offen offset:1024 sc1 lds
  s_waitcnt vmcnt(4)
  s_barrier
  s_add_u32 m0, s33, 122880
  s_add_u32 s36, s32, 20480
  buffer_load_dwordx4 v2, s[8:11], s36 offen sc1 lds
  buffer_load_dwordx4 v2, s[8:11], s36 offen offset:1024 sc1 lds
  s_add_u32 m0, s33, 131072
  s_add_u32 s36, s32, 24576
  buffer_load_dwordx4 v2, s[8:11], s36 offen sc1 lds
  buffer_load_dwordx4 v2, s[8:11], s36 offen offset:1024 sc1 lds
  s_add_u32 m0, s33, 139264
  s_add_u32 s36, s32, 28672
  buffer_load_dwordx4 v2, s[8:11], s36 offen sc1 lds
  buffer_load_dwordx4 v2, s[8:11], s36 offen offset:1024 sc1 lds
  s_waitcnt vmcnt(8)
  s_barrier
  s_add_u32 m0, s33, 147456
  s_add_u32 s36, s32, 32768
  buffer_load_dwordx4 v2, s[8:11], s36 offen sc1 lds
  buffer_load_dwordx4 v2, s[8:11], s36 offen offset:1024 sc1 lds
  s_waitcnt vmcnt(6)
  s_barrier
  s_add_u32 m0, s33, 81920
  s_add_u32 s36, s32, 36864
  buffer_load_dwordx4 v2, s[8:11], s36 offen sc1 lds
  buffer_load_dwordx4 v2, s[8:11], s36 offen offset:1024 sc1 lds
  s_add_u32 m0, s33, 90112
  s_add_u32 s36, s32, 40960
  buffer_load_dwordx4 v2, s[8:11], s36 offen sc1 lds
  buffer_load_dwordx4 v2, s[8:11], s36 offen offset:1024 sc1 lds
  s_add_u32 m0, s35, 0
  s_add_u32 s36, s34, 655360
  buffer_load_dwordx4 v3, s[12:15], s36 offen lds
  buffer_load_dwordx4 v13, s[12:15], s36 offen offset:1024 lds
  s_waitcnt vmcnt(8)
  s_barrier
  s_add_u32 m0, s33, 98304
  s_add_u32 s36, s32, 45056
  buffer_load_dwordx4 v2, s[8:11], s36 offen sc1 lds
  buffer_load_dwordx4 v2, s[8:11], s36 offen offset:1024 sc1 lds
  s_add_u32 m0, s33, 106496
  s_add_u32 s36, s32, 49152
  buffer_load_dwordx4 v2, s[8:11], s36 offen sc1 lds
  buffer_load_dwordx4 v2, s[8:11], s36 offen offset:1024 sc1 lds
  s_add_u32 m0, s35, 16384
  s_add_u32 s36, s34, 786432
  buffer_load_dwordx4 v3, s[12:15], s36 offen lds
  buffer_load_dwordx4 v13, s[12:15], s36 offen offset:1024 lds
  s_waitcnt vmcnt(10)
  s_barrier
  s_add_u32 m0, s33, 114688
  s_add_u32 s36, s32, 53248
  buffer_load_dwordx4 v2, s[8:11], s36 offen sc1 lds
  buffer_load_dwordx4 v2, s[8:11], s36 offen offset:1024 sc1 lds
  s_add_u32 m0, s33, 122880
  s_add_u32 s36, s32, 57344
  buffer_load_dwordx4 v2, s[8:11], s36 offen sc1 lds
  buffer_load_dwordx4 v2, s[8:11], s36 offen offset:1024 sc1 lds
  s_add_u32 m0, s35, 32768
  s_add_u32 s36, s34, 917504
  buffer_load_dwordx4 v3, s[12:15], s36 offen lds
  buffer_load_dwordx4 v13, s[12:15], s36 offen offset:1024 lds
  s_waitcnt vmcnt(10)
  s_barrier
  s_add_u32 m0, s33, 131072
  s_add_u32 s36, s32, 61440
  buffer_load_dwordx4 v2, s[8:11], s36 offen sc1 lds
  buffer_load_dwordx4 v2, s[8:11], s36 offen offset:1024 sc1 lds
  s_add_u32 m0, s33, 139264
  s_add_u32 s36, s32, 65536
  buffer_load_dwordx4 v2, s[8:11], s36 offen sc1 lds
  buffer_load_dwordx4 v2, s[8:11], s36 offen offset:1024 sc1 lds
  s_add_u32 m0, s35, 49152
  s_add_u32 s36, s34, 1048576
  buffer_load_dwordx4 v3, s[12:15], s36 offen lds
  buffer_load_dwordx4 v13, s[12:15], s36 offen offset:1024 lds
  s_waitcnt vmcnt(10)
  s_barrier
  s_add_u32 m0, s33, 147456
  s_add_u32 s36, s32, 69632
  buffer_load_dwordx4 v2, s[8:11], s36 offen sc1 lds
  buffer_load_dwordx4 v2, s[8:11], s36 offen offset:1024 sc1 lds
  s_add_u32 m0, s33, 81920
  s_add_u32 s36, s32, 73728
  buffer_load_dwordx4 v2, s[8:11], s36 offen sc1 lds
  buffer_load_dwordx4 v2, s[8:11], s36 offen offset:1024 sc1 lds
  s_add_u32 m0, s35, 65536
  s_add_u32 s36, s34, 1179648
  buffer_load_dwordx4 v3, s[12:15], s36 offen lds
  buffer_load_dwordx4 v13, s[12:15], s36 offen offset:1024 lds
  s_waitcnt vmcnt(10)
  s_barrier
  s_add_u32 m0, s33, 90112
  s_add_u32 s36, s32, 77824
  buffer_load_dwordx4 v2, s[8:11], s36 offen sc1 lds
  buffer_load_dwordx4 v2, s[8:11], s36 offen offset:1024 sc1 lds
  s_add_u32 m0, s33, 98304
  s_add_u32 s36, s32, 81920
  buffer_load_dwordx4 v2, s[8:11], s36 offen sc1 lds
  buffer_load_dwordx4 v2, s[8:11], s36 offen offset:1024 sc1 lds
  s_add_u32 m0, s35, 0
  s_add_u32 s36, s34, 1310720
  buffer_load_dwordx4 v3, s[12:15], s36 offen lds
  buffer_load_dwordx4 v13, s[12:15], s36 offen offset:1024 lds
  s_waitcnt vmcnt(10)
  s_barrier
  s_add_u32 m0, s33, 106496
  s_add_u32 s36, s32, 86016
  buffer_load_dwordx4 v2, s[8:11], s36 offen sc1 lds
  buffer_load_dwordx4 v2, s[8:11], s36 offen offset:1024 sc1 lds
  s_add_u32 m0, s33, 114688
  s_add_u32 s36, s32, 90112
  buffer_load_dwordx4 v2, s[8:11], s36 offen sc1 lds
  buffer_load_dwordx4 v2, s[8:11], s36 offen offset:1024 sc1 lds
  s_add_u32 m0, s35, 16384
  s_add_u32 s36, s34, 1441792
  buffer_load_dwordx4 v3, s[12:15], s36 offen lds
  buffer_load_dwordx4 v13, s[12:15], s36 offen offset:1024 lds
  s_waitcnt vmcnt(10)
  s_barrier
  s_add_u32 m0, s33, 122880
  s_add_u32 s36, s32, 94208
  buffer_load_dwordx4 v2, s[8:11], s36 offen sc1 lds
  buffer_load_dwordx4 v2, s[8:11], s36 offen offset:1024 sc1 lds
  s_add_u32 m0, s33, 131072
  s_add_u32 s36, s32, 98304
  buffer_load_dwordx4 v2, s[8:11], s36 offen sc1 lds
  buffer_load_dwordx4 v2, s[8:11], s36 offen offset:1024 sc1 lds
  s_add_u32 m0, s35, 32768
  s_add_u32 s36, s34, 1572864
  buffer_load_dwordx4 v3, s[12:15], s36 offen lds
  buffer_load_dwordx4 v13, s[12:15], s36 offen offset:1024 lds
  s_waitcnt vmcnt(10)
  s_barrier
  s_add_u32 m0, s33, 139264
  s_add_u32 s36, s32, 102400
  buffer_load_dwordx4 v2, s[8:11], s36 offen sc1 lds
  buffer_load_dwordx4 v2, s[8:11], s36 offen offset:1024 sc1 lds
  s_add_u32 m0, s33, 147456
  s_add_u32 s36, s32, 106496
  buffer_load_dwordx4 v2, s[8:11], s36 offen sc1 lds
  buffer_load_dwordx4 v2, s[8:11], s36 offen offset:1024 sc1 lds
  s_add_u32 m0, s35, 49152
  s_add_u32 s36, s34, 1703936
  buffer_load_dwordx4 v3, s[12:15], s36 offen lds
  buffer_load_dwordx4 v13, s[12:15], s36 offen offset:1024 lds
  s_waitcnt vmcnt(10)
  s_barrier
  s_add_u32 m0, s33, 81920
  s_add_u32 s36, s32, 110592
  buffer_load_dwordx4 v2, s[8:11], s36 offen sc1 lds
  buffer_load_dwordx4 v2, s[8:11], s36 offen offset:1024 sc1 lds
  s_waitcnt vmcnt(6)
  s_barrier
  s_waitcnt vmcnt(0)
  s_barrier
  s_barrier
P5_join:
E_exit:
  s_endpgm
P2_slow:
  s_add_u32 m0, s34, 8192
  s_add_u32 s36, s35, 2105344
  buffer_load_dwordx4 v2, s[8:11], s36 offen sc1 lds
  s_add_u32 m0, s34, 73728
  s_add_u32 s36, s35, 4202496
  buffer_load_dwordx4 v2, s[8:11], s36 offen sc1 lds
  s_add_u32 m0, s34, 40960
  s_add_u32 s36, s35, 2138112
  buffer_load_dwordx4 v2, s[8:11], s36 offen sc1 lds
  s_add_u32 m0, s34, 106496
  s_add_u32 s36, s35, 4235264
  buffer_load_dwordx4 v2, s[8:11], s36 offen sc1 lds
  s_add_u32 m0, s34, 16384
  s_add_u32 s36, s35, 2113536
  buffer_load_dwordx4 v2, s[8:11], s36 offen sc1 lds
  s_add_u32 m0, s34, 81920
  s_add_u32 s36, s35, 4210688
  buffer_load_dwordx4 v2, s[8:11], s36 offen sc1 lds
  s_add_u32 m0, s34, 49152
  s_add_u32 s36, s35, 2146304
  buffer_load_dwordx4 v2, s[8:11], s36 offen sc1 lds
  s_add_u32 m0, s34, 114688
  s_add_u32 s36, s35, 4243456
  buffer_load_dwordx4 v2, s[8:11], s36 offen sc1 lds
  s_add_u32 m0, s34, 24576
  s_add_u32 s36, s35, 2121728
  buffer_load_dwordx4 v2, s[8:11], s36 offen sc1 lds
  s_add_u32 m0, s34, 90112
  s_add_u32 s36, s35, 4218880
  buffer_load_dwordx4 v2, s[8:11], s36 offen sc1 lds
  s_add_u32 m0, s34, 57344
  s_add_u32 s36, s35, 2154496
  buffer_load_dwordx4 v2, s[8:11], s36 offen sc1 lds
  s_add_u32 m0, s34, 122880
  s_add_u32 s36, s35, 4251648
  buffer_load_dwordx4 v2, s[8:11], s36 offen sc1 lds
  s_waitcnt vmcnt(0)
  s_barrier
  v_mov_b32 v12, 0xff800000
  v_mov_b32 v13, 0xff800000
  s_mov_b32 s44, 0
  v_mov_b32 v14, v2
P2_maxloop:
  ds_read_b128 v[16:19], v14
  v_add_u32 v14, 1024, v14
  s_waitcnt lgkmcnt(0)
  v_mfma_f32_32x32x16_bf16 v[40:55], v[16:19], v[4:7], 0
  v_mfma_f32_32x32x16_bf16 v[56:71], v[16:19], v[8:11], 0
  s_nop 15
  v_max3_f32 v12, v40, v41, v12
  v_max3_f32 v12, v42, v43, v12
  v_max3_f32 v12, v44, v45, v12
  v_max3_f32 v12, v46, v47, v12
  v_max3_f32 v12, v48, v49, v12
  v_max3_f32 v12, v50, v51, v12
  v_max3_f32 v12, v52, v53, v12
  v_max3_f32 v12, v54, v55, v12
  v_max3_f32 v13, v56, v57, v13
  v_max3_f32 v13, v58, v59, v13
  v_max3_f32 v13, v60, v61, v13
  v_max3_f32 v13, v62, v63, v13
  v_max3_f32 v13, v64, v65, v13
  v_max3_f32 v13, v66, v67, v13
  v_max3_f32 v13, v68, v69, v13
  v_max3_f32 v13, v70, v71, v13
  s_add_u32 s44, s44, 1
  s_cmp_lt_u32 s44, 64
  s_cbranch_scc1 P2_maxloop
  v_mov_b32 v14, v12
  s_nop 1
  v_permlane32_swap_b32 v12, v14
  s_nop 1
  v_max_f32 v12, v12, v14
  v_mov_b32 v14, v13
  s_nop 1
  v_permlane32_swap_b32 v13, v14
  s_nop 1
  v_max_f32 v13, v13, v14
  v_sub_f32 v12, 0, v12
  v_sub_f32 v13, 0, v13
  v_mov_b32 v104, v12
  v_mov_b32 v120, v13
  v_mov_b32 v105, v12
  v_mov_b32 v121, v13
  v_mov_b32 v106, v12
  v_mov_b32 v122, v13
  v_mov_b32 v107, v12
  v_mov_b32 v123, v13
  v_mov_b32 v108, v12
  v_mov_b32 v124, v13
  v_mov_b32 v109, v12
  v_mov_b32 v125, v13
  v_mov_b32 v110, v12
  v_mov_b32 v126, v13
  v_mov_b32 v111, v12
  v_mov_b32 v127, v13
  v_mov_b32 v112, v12
  v_mov_b32 v128, v13
  v_mov_b32 v113, v12
  v_mov_b32 v129, v13
  v_mov_b32 v114, v12
  v_mov_b32 v130, v13
  v_mov_b32 v115, v12
  v_mov_b32 v131, v13
  v_mov_b32 v116, v12
  v_mov_b32 v132, v13
  v_mov_b32 v117, v12
  v_mov_b32 v133, v13
  v_mov_b32 v118, v12
  v_mov_b32 v134, v13
  v_mov_b32 v119, v12
  v_mov_b32 v135, v13
  s_barrier
  s_waitcnt vmcnt(0)
  s_barrier
  ds_read_b128 v[16:19], v137 offset:0
  ds_read_b128 v[20:23], v137 offset:1024
  s_mov_b64 exec, s[40:41]
  ds_read_b128 v[24:27], v138 offset:0
  ds_read_b128 v[28:31], v138 offset:512
  s_mov_b64 exec, -1
  s_waitcnt lgkmcnt(3)
  v_mfma_f32_32x32x16_bf16 v[40:55], v[16:19], v[4:7], v[104:119]
  v_mfma_f32_32x32x16_bf16 v[56:71], v[16:19], v[8:11], v[120:135]
  s_mov_b64 exec, s[40:41]
  ds_read_b128 v[32:35], v138 offset:1024
  ds_read_b128 v[36:39], v138 offset:1536
  s_mov_b64 exec, -1
  ds_read_b128 v[16:19], v137 offset:2048
  s_nop 7
  v_exp_f32 v40, v40
  v_exp_f32 v41, v41
  v_exp_f32 v42, v42
  v_exp_f32 v43, v43
  v_exp_f32 v44, v44
  v_exp_f32 v45, v45
  v_exp_f32 v46, v46
  v_exp_f32 v47, v47
  v_exp_f32 v48, v48
  v_exp_f32 v49, v49
  v_exp_f32 v50, v50
  v_exp_f32 v51, v51
  s_waitcnt lgkmcnt(3)
  v_smfmac_f32_32x32x32_bf16 v[72:87], v[24:27], v[40:47], v136
  v_exp_f32 v52, v52
  v_exp_f32 v53, v53
  s_add_u32 m0, s34, 8192
  s_add_u32 s36, s35, 2105344
  buffer_load_dwordx4 v2, s[8:11], s36 offen sc1 lds
  v_exp_f32 v54, v54
  v_exp_f32 v55, v55
  v_exp_f32 v56, v56
  v_exp_f32 v57, v57
  v_smfmac_f32_32x32x32_bf16 v[72:87], v[28:31], v[48:55], v136
  v_exp_f32 v58, v58
  v_exp_f32 v59, v59
  v_exp_f32 v60, v60
  v_exp_f32 v61, v61
  s_waitcnt lgkmcnt(0)
  v_exp_f32 v62, v62
  v_mfma_f32_32x32x16_bf16 v[40:55], v[20:23], v[4:7], v[104:119]
  v_exp_f32 v63, v63
  v_exp_f32 v64, v64
  v_exp_f32 v65, v65
  v_exp_f32 v66, v66
  v_exp_f32 v67, v67
  v_smfmac_f32_32x32x32_bf16 v[88:103], v[24:27], v[56:63], v136
  v_exp_f32 v68, v68
  v_exp_f32 v69, v69
  s_add_u32 m0, s34, 73728
  s_add_u32 s36, s35, 4202496
  buffer_load_dwordx4 v2, s[8:11], s36 offen sc1 lds
  v_exp_f32 v70, v70
  v_exp_f32 v71, v71
  v_exp_f32 v40, v40
  v_exp_f32 v41, v41
  v_smfmac_f32_32x32x32_bf16 v[88:103], v[28:31], v[64:71], v136
  s_mov_b64 exec, s[40:41]
  ds_read_b128 v[24:27], v138 offset:2048
  ds_read_b128 v[28:31], v138 offset:2560
  s_mov_b64 exec, -1
  v_exp_f32 v42, v42
  v_exp_f32 v43, v43
  v_exp_f32 v44, v44
  v_exp_f32 v45, v45
  v_exp_f32 v46, v46
  v_mfma_f32_32x32x16_bf16 v[56:71], v[20:23], v[8:11], v[120:135]
  ds_read_b128 v[20:23], v137 offset:3072
  v_exp_f32 v47, v47
  v_exp_f32 v48, v48
  v_exp_f32 v49, v49
  v_exp_f32 v50, v50
  v_exp_f32 v51, v51
  v_smfmac_f32_32x32x32_bf16 v[72:87], v[32:35], v[40:47], v136
  v_exp_f32 v52, v52
  v_exp_f32 v53, v53
  s_add_u32 m0, s34, 40960
  s_add_u32 s36, s35, 2138112
  buffer_load_dwordx4 v2, s[8:11], s36 offen sc1 lds
  v_exp_f32 v54, v54
  v_exp_f32 v55, v55
  v_exp_f32 v56, v56
  v_exp_f32 v57, v57
  v_smfmac_f32_32x32x32_bf16 v[72:87], v[36:39], v[48:55], v136
  v_exp_f32 v58, v58
  v_exp_f32 v59, v59
  v_exp_f32 v60, v60
  v_exp_f32 v61, v61
  s_waitcnt lgkmcnt(0)
  v_exp_f32 v62, v62
  v_mfma_f32_32x32x16_bf16 v[40:55], v[16:19], v[4:7], v[104:119]
  v_exp_f32 v63, v63
  v_exp_f32 v64, v64
  v_exp_f32 v65, v65
  v_exp_f32 v66, v66
  v_exp_f32 v67, v67
  v_smfmac_f32_32x32x32_bf16 v[88:103], v[32:35], v[56:63], v136
  v_exp_f32 v68, v68
  v_exp_f32 v69, v69
  s_add_u32 m0, s34, 106496
  s_add_u32 s36, s35, 4235264
  buffer_load_dwordx4 v2, s[8:11], s36 offen sc1 lds
  v_exp_f32 v70, v70
  v_exp_f32 v71, v71
  v_exp_f32 v40, v40
  v_exp_f32 v41, v41
  v_smfmac_f32_32x32x32_bf16 v[88:103], v[36:39], v[64:71], v136
  s_mov_b64 exec, s[40:41]
  ds_read_b128 v[32:35], v138 offset:3072
  ds_read_b128 v[36:39], v138 offset:3584
  s_mov_b64 exec, -1
  v_exp_f32 v42, v42
  v_exp_f32 v43, v43
  v_exp_f32 v44, v44
  v_exp_f32 v45, v45
  v_exp_f32 v46, v46
  v_mfma_f32_32x32x16_bf16 v[56:71], v[16:19], v[8:11], v[120:135]
  ds_read_b128 v[16:19], v137 offset:4096
  v_exp_f32 v47, v47
  v_exp_f32 v48, v48
  v_exp_f32 v49, v49
  v_exp_f32 v50, v50
  v_exp_f32 v51, v51
  v_smfmac_f32_32x32x32_bf16 v[72:87], v[24:27], v[40:47], v136
  v_exp_f32 v52, v52
  v_exp_f32 v53, v53
  s_add_u32 m0, s34, 16384
  s_add_u32 s36, s35, 2113536
  buffer_load_dwordx4 v2, s[8:11], s36 offen sc1 lds
  v_exp_f32 v54, v54
  v_exp_f32 v55, v55
  v_exp_f32 v56, v56
  v_exp_f32 v57, v57
  v_smfmac_f32_32x32x32_bf16 v[72:87], v[28:31], v[48:55], v136
  v_exp_f32 v58, v58
  v_exp_f32 v59, v59
  v_exp_f32 v60, v60
  v_exp_f32 v61, v61
  s_waitcnt lgkmcnt(0)
  v_exp_f32 v62, v62
  v_mfma_f32_32x32x16_bf16 v[40:55], v[20:23], v[4:7], v[104:119]
  v_exp_f32 v63, v63
  v_exp_f32 v64, v64
  v_exp_f32 v65, v65
  v_exp_f32 v66, v66
  v_exp_f32 v67, v67
  v_smfmac_f32_32x32x32_bf16 v[88:103], v[24:27], v[56:63], v136
  v_exp_f32 v68, v68
  v_exp_f32 v69, v69
  s_add_u32 m0, s34, 81920
  s_add_u32 s36, s35, 4210688
  buffer_load_dwordx4 v2, s[8:11], s36 offen sc1 lds
  v_exp_f32 v70, v70
  v_exp_f32 v71, v71
  v_exp_f32 v40, v40
  v_exp_f32 v41, v41
  v_smfmac_f32_32x32x32_bf16 v[88:103], v[28:31], v[64:71], v136
  s_mov_b64 exec, s[40:41]
  ds_read_b128 v[24:27], v138 offset:4096
  ds_read_b128 v[28:31], v138 offset:4608
  s_mov_b64 exec, -1
  v_exp_f32 v42, v42
  v_exp_f32 v43, v43
  v_exp_f32 v44, v44
  v_exp_f32 v45, v45
  v_exp_f32 v46, v46
  v_mfma_f32_32x32x16_bf16 v[56:71], v[20:23], v[8:11], v[120:135]
  ds_read_b128 v[20:23], v137 offset:5120
  v_exp_f32 v47, v47
  v_exp_f32 v48, v48
  v_exp_f32 v49, v49
  v_exp_f32 v50, v50
  v_exp_f32 v51, v51
  v_smfmac_f32_32x32x32_bf16 v[72:87], v[32:35], v[40:47], v136
  v_exp_f32 v52, v52
  v_exp_f32 v53, v53
  s_add_u32 m0, s34, 49152
  s_add_u32 s36, s35, 2146304
  buffer_load_dwordx4 v2, s[8:11], s36 offen sc1 lds
  v_exp_f32 v54, v54
  v_exp_f32 v55, v55
  v_exp_f32 v56, v56
  v_exp_f32 v57, v57
  v_smfmac_f32_32x32x32_bf16 v[72:87], v[36:39], v[48:55], v136
  v_exp_f32 v58, v58
  v_exp_f32 v59, v59
  v_exp_f32 v60, v60
  v_exp_f32 v61, v61
  s_waitcnt lgkmcnt(0)
  v_exp_f32 v62, v62
  v_mfma_f32_32x32x16_bf16 v[40:55], v[16:19], v[4:7], v[104:119]
  v_exp_f32 v63, v63
  v_exp_f32 v64, v64
  v_exp_f32 v65, v65
  v_exp_f32 v66, v66
  v_exp_f32 v67, v67
  v_smfmac_f32_32x32x32_bf16 v[88:103], v[32:35], v[56:63], v136
  v_exp_f32 v68, v68
  v_exp_f32 v69, v69
  s_add_u32 m0, s34, 114688
  s_add_u32 s36, s35, 4243456
  buffer_load_dwordx4 v2, s[8:11], s36 offen sc1 lds
  v_exp_f32 v70, v70
  v_exp_f32 v71, v71
  v_exp_f32 v40, v40
  v_exp_f32 v41, v41
  v_smfmac_f32_32x32x32_bf16 v[88:103], v[36:39], v[64:71], v136
  s_mov_b64 exec, s[40:41]
  ds_read_b128 v[32:35], v138 offset:5120
  ds_read_b128 v[36:39], v138 offset:5632
  s_mov_b64 exec, -1
  v_exp_f32 v42, v42
  v_exp_f32 v43, v43
  v_exp_f32 v44, v44
  v_exp_f32 v45, v45
  v_exp_f32 v46, v46
  v_mfma_f32_32x32x16_bf16 v[56:71], v[16:19], v[8:11], v[120:135]
  ds_read_b128 v[16:19], v137 offset:6144
  v_exp_f32 v47, v47
  v_exp_f32 v48, v48
  v_exp_f32 v49, v49
  v_exp_f32 v50, v50
  v_exp_f32 v51, v51
  v_smfmac_f32_32x32x32_bf16 v[72:87], v[24:27], v[40:47], v136
  v_exp_f32 v52, v52
  v_exp_f32 v53, v53
  s_add_u32 m0, s34, 24576
  s_add_u32 s36, s35, 2121728
  buffer_load_dwordx4 v2, s[8:11], s36 offen sc1 lds
  v_exp_f32 v54, v54
  v_exp_f32 v55, v55
  v_exp_f32 v56, v56
  v_exp_f32 v57, v57
  v_smfmac_f32_32x32x32_bf16 v[72:87], v[28:31], v[48:55], v136
  v_exp_f32 v58, v58
  v_exp_f32 v59, v59
  v_exp_f32 v60, v60
  v_exp_f32 v61, v61
  s_waitcnt lgkmcnt(0)
  v_exp_f32 v62, v62
  v_mfma_f32_32x32x16_bf16 v[40:55], v[20:23], v[4:7], v[104:119]
  v_exp_f32 v63, v63
  v_exp_f32 v64, v64
  v_exp_f32 v65, v65
  v_exp_f32 v66, v66
  v_exp_f32 v67, v67
  v_smfmac_f32_32x32x32_bf16 v[88:103], v[24:27], v[56:63], v136
  v_exp_f32 v68, v68
  v_exp_f32 v69, v69
  s_add_u32 m0, s34, 90112
  s_add_u32 s36, s35, 4218880
  buffer_load_dwordx4 v2, s[8:11], s36 offen sc1 lds
  v_exp_f32 v70, v70
  v_exp_f32 v71, v71
  v_exp_f32 v40, v40
  v_exp_f32 v41, v41
  v_smfmac_f32_32x32x32_bf16 v[88:103], v[28:31], v[64:71], v136
  s_mov_b64 exec, s[40:41]
  ds_read_b128 v[24:27], v138 offset:6144
  ds_read_b128 v[28:31], v138 offset:6656
  s_mov_b64 exec, -1
  v_exp_f32 v42, v42
  v_exp_f32 v43, v43
  v_exp_f32 v44, v44
  v_exp_f32 v45, v45
  v_exp_f32 v46, v46
  v_mfma_f32_32x32x16_bf16 v[56:71], v[20:23], v[8:11], v[120:135]
  ds_read_b128 v[20:23], v137 offset:7168
  v_exp_f32 v47, v47
  v_exp_f32 v48, v48
  v_exp_f32 v49, v49
  v_exp_f32 v50, v50
  v_exp_f32 v51, v51
  v_smfmac_f32_32x32x32_bf16 v[72:87], v[32:35], v[40:47], v136
  v_exp_f32 v52, v52
  v_exp_f32 v53, v53
  s_add_u32 m0, s34, 57344
  s_add_u32 s36, s35, 2154496
  buffer_load_dwordx4 v2, s[8:11], s36 offen sc1 lds
  v_exp_f32 v54, v54
  v_exp_f32 v55, v55
  v_exp_f32 v56, v56
  v_exp_f32 v57, v57
  v_smfmac_f32_32x32x32_bf16 v[72:87], v[36:39], v[48:55], v136
  v_exp_f32 v58, v58
  v_exp_f32 v59, v59
  v_exp_f32 v60, v60
  v_exp_f32 v61, v61
  s_waitcnt lgkmcnt(0)
  v_exp_f32 v62, v62
  v_mfma_f32_32x32x16_bf16 v[40:55], v[16:19], v[4:7], v[104:119]
  v_exp_f32 v63, v63
  v_exp_f32 v64, v64
  v_exp_f32 v65, v65
  v_exp_f32 v66, v66
  v_exp_f32 v67, v67
  v_smfmac_f32_32x32x32_bf16 v[88:103], v[32:35], v[56:63], v136
  v_exp_f32 v68, v68
  v_exp_f32 v69, v69
  s_add_u32 m0, s34, 122880
  s_add_u32 s36, s35, 4251648
  buffer_load_dwordx4 v2, s[8:11], s36 offen sc1 lds
  v_exp_f32 v70, v70
  v_exp_f32 v71, v71
  s_waitcnt vmcnt(8)
  s_barrier
  v_exp_f32 v40, v40
  v_exp_f32 v41, v41
  v_smfmac_f32_32x32x32_bf16 v[88:103], v[36:39], v[64:71], v136
  s_mov_b64 exec, s[40:41]
  ds_read_b128 v[32:35], v138 offset:7168
  ds_read_b128 v[36:39], v138 offset:7680
  s_mov_b64 exec, -1
  v_exp_f32 v42, v42
  v_exp_f32 v43, v43
  v_exp_f32 v44, v44
  v_exp_f32 v45, v45
  v_exp_f32 v46, v46
  v_mfma_f32_32x32x16_bf16 v[56:71], v[16:19], v[8:11], v[120:135]
  ds_read_b128 v[16:19], v137 offset:8192
  v_exp_f32 v47, v47
  v_exp_f32 v48, v48
  v_exp_f32 v49, v49
  v_exp_f32 v50, v50
  v_exp_f32 v51, v51
  v_smfmac_f32_32x32x32_bf16 v[72:87], v[24:27], v[40:47], v136
  v_exp_f32 v52, v52
  v_exp_f32 v53, v53
  s_lshl_b32 s56, s28, 3
  s_add_u32 s56, s56, s24
  s_lshl_b32 s56, s56, 13
  v_lshlrev_b32 v139, 7, v1
  s_mov_b32 s60, s68
  s_and_b32 s61, s69, 0xffff
  s_mov_b32 s62, 524288
  s_mov_b32 s63, 0x20000
  buffer_load_dword v252, v139, s[60:63], s56 offen
  v_exp_f32 v54, v54
  v_exp_f32 v55, v55
  v_exp_f32 v56, v56
  v_exp_f32 v57, v57
  v_smfmac_f32_32x32x32_bf16 v[72:87], v[28:31], v[48:55], v136
  v_exp_f32 v58, v58
  v_exp_f32 v59, v59
  v_exp_f32 v60, v60
  v_exp_f32 v61, v61
  s_waitcnt lgkmcnt(0)
  v_exp_f32 v62, v62
  v_mfma_f32_32x32x16_bf16 v[40:55], v[20:23], v[4:7], v[104:119]
  v_exp_f32 v63, v63
  v_exp_f32 v64, v64
  v_exp_f32 v65, v65
  v_exp_f32 v66, v66
  v_exp_f32 v67, v67
  v_smfmac_f32_32x32x32_bf16 v[88:103], v[24:27], v[56:63], v136
  v_exp_f32 v68, v68
  v_exp_f32 v69, v69
  s_mov_b32 s60, s72
  s_and_b32 s61, s73, 0xffff
  s_mov_b32 s62, 1835008
  s_mov_b32 s63, 0x20000
  buffer_load_dword v252, v139, s[60:63], s56 offen
  v_exp_f32 v70, v70
  v_exp_f32 v71, v71
  v_exp_f32 v40, v40
  v_exp_f32 v41, v41
  v_smfmac_f32_32x32x32_bf16 v[88:103], v[28:31], v[64:71], v136
  s_mov_b64 exec, s[40:41]
  ds_read_b128 v[24:27], v138 offset:8192
  ds_read_b128 v[28:31], v138 offset:8704
  s_mov_b64 exec, -1
  v_exp_f32 v42, v42
  v_exp_f32 v43, v43
  v_exp_f32 v44, v44
  v_exp_f32 v45, v45
  v_exp_f32 v46, v46
  v_mfma_f32_32x32x16_bf16 v[56:71], v[20:23], v[8:11], v[120:135]
  ds_read_b128 v[20:23], v137 offset:9216
  v_exp_f32 v47, v47
  v_exp_f32 v48, v48
  v_exp_f32 v49, v49
  v_exp_f32 v50, v50
  v_exp_f32 v51, v51
  v_smfmac_f32_32x32x32_bf16 v[72:87], v[32:35], v[40:47], v136
  v_exp_f32 v52, v52
  v_exp_f32 v53, v53
  v_exp_f32 v54, v54
  v_exp_f32 v55, v55
  v_exp_f32 v56, v56
  v_exp_f32 v57, v57
  v_smfmac_f32_32x32x32_bf16 v[72:87], v[36:39], v[48:55], v136
  v_exp_f32 v58, v58
  v_exp_f32 v59, v59
  v_exp_f32 v60, v60
  v_exp_f32 v61, v61
  s_waitcnt lgkmcnt(0)
  v_exp_f32 v62, v62
  v_mfma_f32_32x32x16_bf16 v[40:55], v[16:19], v[4:7], v[104:119]
  v_exp_f32 v63, v63
  v_exp_f32 v64, v64
  v_exp_f32 v65, v65
  v_exp_f32 v66, v66
  v_exp_f32 v67, v67
  v_smfmac_f32_32x32x32_bf16 v[88:103], v[32:35], v[56:63], v136
  v_exp_f32 v68, v68
  v_exp_f32 v69, v69
  s_mov_b32 s60, s76
  s_and_b32 s61, s77, 0xffff
  s_mov_b32 s62, 1835008
  s_mov_b32 s63, 0x20000
  s_lshl_b32 s56, s2, 13
  s_cmp_eq_u32 s24, 0
  s_cselect_b32 s56, s56, 0x7fff0000
  buffer_load_dword v252, v139, s[60:63], s56 offen
  v_exp_f32 v70, v70
  v_exp_f32 v71, v71
  v_add_u32 v137, 8192, v137
  v_add_u32 v138, 8192, v138
  s_mov_b32 s44, 0
  .p2align 6
P2_loop_s:
  v_exp_f32 v40, v40
  v_exp_f32 v41, v41
  v_smfmac_f32_32x32x32_bf16 v[88:103], v[36:39], v[64:71], v136
  s_mov_b64 exec, s[40:41]
  ds_read_b128 v[32:35], v138 offset:1024
  ds_read_b128 v[36:39], v138 offset:1536
  s_mov_b64 exec, -1
  v_exp_f32 v42, v42
  v_exp_f32 v43, v43
  v_exp_f32 v44, v44
  v_exp_f32 v45, v45
  v_exp_f32 v46, v46
  v_mfma_f32_32x32x16_bf16 v[56:71], v[16:19], v[8:11], v[120:135]
  ds_read_b128 v[16:19], v137 offset:2048
  v_exp_f32 v47, v47
  v_exp_f32 v48, v48
  v_exp_f32 v49, v49
  v_exp_f32 v50, v50
  v_exp_f32 v51, v51
  v_smfmac_f32_32x32x32_bf16 v[72:87], v[24:27], v[40:47], v136
  v_exp_f32 v52, v52
  v_exp_f32 v53, v53
  v_exp_f32 v54, v54
  v_exp_f32 v55, v55
  v_exp_f32 v56, v56
  v_exp_f32 v57, v57
  v_smfmac_f32_32x32x32_bf16 v[72:87], v[28:31], v[48:55], v136
  v_exp_f32 v58, v58
  v_exp_f32 v59, v59
  v_exp_f32 v60, v60
  v_exp_f32 v61, v61
  s_waitcnt lgkmcnt(0)
  v_exp_f32 v62, v62
  v_mfma_f32_32x32x16_bf16 v[40:55], v[20:23], v[4:7], v[104:119]
  v_exp_f32 v63, v63
  v_exp_f32 v64, v64
  v_exp_f32 v65, v65
  v_exp_f32 v66, v66
  v_exp_f32 v67, v67
  v_smfmac_f32_32x32x32_bf16 v[88:103], v[24:27], v[56:63], v136
  v_exp_f32 v68, v68
  v_exp_f32 v69, v69
  v_exp_f32 v70, v70
  v_exp_f32 v71, v71
  v_exp_f32 v40, v40
  v_exp_f32 v41, v41
  v_smfmac_f32_32x32x32_bf16 v[88:103], v[28:31], v[64:71], v136
  s_mov_b64 exec, s[40:41]
  ds_read_b128 v[24:27], v138 offset:2048
  ds_read_b128 v[28:31], v138 offset:2560
  s_mov_b64 exec, -1
  v_exp_f32 v42, v42
  v_exp_f32 v43, v43
  v_exp_f32 v44, v44
  v_exp_f32 v45, v45
  v_exp_f32 v46, v46
  v_mfma_f32_32x32x16_bf16 v[56:71], v[20:23], v[8:11], v[120:135]
  ds_read_b128 v[20:23], v137 offset:3072
  v_exp_f32 v47, v47
  v_exp_f32 v48, v48
  v_exp_f32 v49, v49
  v_exp_f32 v50, v50
  v_exp_f32 v51, v51
  v_smfmac_f32_32x32x32_bf16 v[72:87], v[32:35], v[40:47], v136
  v_exp_f32 v52, v52
  v_exp_f32 v53, v53
  v_exp_f32 v54, v54
  v_exp_f32 v55, v55
  v_exp_f32 v56, v56
  v_exp_f32 v57, v57
  v_smfmac_f32_32x32x32_bf16 v[72:87], v[36:39], v[48:55], v136
  v_exp_f32 v58, v58
  v_exp_f32 v59, v59
  v_exp_f32 v60, v60
  v_exp_f32 v61, v61
  s_waitcnt lgkmcnt(0)
  v_exp_f32 v62, v62
  v_mfma_f32_32x32x16_bf16 v[40:55], v[16:19], v[4:7], v[104:119]
  v_exp_f32 v63, v63
  v_exp_f32 v64, v64
  v_exp_f32 v65, v65
  v_exp_f32 v66, v66
  v_exp_f32 v67, v67
  v_smfmac_f32_32x32x32_bf16 v[88:103], v[32:35], v[56:63], v136
  v_exp_f32 v68, v68
  v_exp_f32 v69, v69
  v_exp_f32 v70, v70
  v_exp_f32 v71, v71
  s_cmp_lg_u32 s44, 1
  s_cbranch_scc1 P2_nosync_s
  s_waitcnt vmcnt(0)
  s_barrier
P2_nosync_s:
  v_exp_f32 v40, v40
  v_exp_f32 v41, v41
  v_smfmac_f32_32x32x32_bf16 v[88:103], v[36:39], v[64:71], v136
  s_mov_b64 exec, s[40:41]
  ds_read_b128 v[32:35], v138 offset:3072
  ds_read_b128 v[36:39], v138 offset:3584
  s_mov_b64 exec, -1
  v_exp_f32 v42, v42
  v_exp_f32 v43, v43
  v_exp_f32 v44, v44
  v_exp_f32 v45, v45
  v_exp_f32 v46, v46
  v_mfma_f32_32x32x16_bf16 v[56:71], v[16:19], v[8:11], v[120:135]
  ds_read_b128 v[16:19], v137 offset:4096
  v_exp_f32 v47, v47
  v_exp_f32 v48, v48
  v_exp_f32 v49, v49
  v_exp_f32 v50, v50
  v_exp_f32 v51, v51
  v_smfmac_f32_32x32x32_bf16 v[72:87], v[24:27], v[40:47], v136
  v_exp_f32 v52, v52
  v_exp_f32 v53, v53
  v_exp_f32 v54, v54
  v_exp_f32 v55, v55
  v_exp_f32 v56, v56
  v_exp_f32 v57, v57
  v_smfmac_f32_32x32x32_bf16 v[72:87], v[28:31], v[48:55], v136
  v_exp_f32 v58, v58
  v_exp_f32 v59, v59
  v_exp_f32 v60, v60
  v_exp_f32 v61, v61
  s_waitcnt lgkmcnt(0)
  v_exp_f32 v62, v62
  v_mfma_f32_32x32x16_bf16 v[40:55], v[20:23], v[4:7], v[104:119]
  v_exp_f32 v63, v63
  v_exp_f32 v64, v64
  v_exp_f32 v65, v65
  v_exp_f32 v66, v66
  v_exp_f32 v67, v67
  v_smfmac_f32_32x32x32_bf16 v[88:103], v[24:27], v[56:63], v136
  v_exp_f32 v68, v68
  v_exp_f32 v69, v69
  v_exp_f32 v70, v70
  v_exp_f32 v71, v71
  v_exp_f32 v40, v40
  v_exp_f32 v41, v41
  v_smfmac_f32_32x32x32_bf16 v[88:103], v[28:31], v[64:71], v136
  s_mov_b64 exec, s[40:41]
  ds_read_b128 v[24:27], v138 offset:4096
  ds_read_b128 v[28:31], v138 offset:4608
  s_mov_b64 exec, -1
  v_exp_f32 v42, v42
  v_exp_f32 v43, v43
  v_exp_f32 v44, v44
  v_exp_f32 v45, v45
  v_exp_f32 v46, v46
  v_mfma_f32_32x32x16_bf16 v[56:71], v[20:23], v[8:11], v[120:135]
  ds_read_b128 v[20:23], v137 offset:5120
  v_exp_f32 v47, v47
  v_exp_f32 v48, v48
  v_exp_f32 v49, v49
  v_exp_f32 v50, v50
  v_exp_f32 v51, v51
  v_smfmac_f32_32x32x32_bf16 v[72:87], v[32:35], v[40:47], v136
  v_exp_f32 v52, v52
  v_exp_f32 v53, v53
  v_exp_f32 v54, v54
  v_exp_f32 v55, v55
  v_exp_f32 v56, v56
  v_exp_f32 v57, v57
  v_smfmac_f32_32x32x32_bf16 v[72:87], v[36:39], v[48:55], v136
  v_exp_f32 v58, v58
  v_exp_f32 v59, v59
  v_exp_f32 v60, v60
  v_exp_f32 v61, v61
  s_waitcnt lgkmcnt(0)
  v_exp_f32 v62, v62
  v_mfma_f32_32x32x16_bf16 v[40:55], v[16:19], v[4:7], v[104:119]
  v_exp_f32 v63, v63
  v_exp_f32 v64, v64
  v_exp_f32 v65, v65
  v_exp_f32 v66, v66
  v_exp_f32 v67, v67
  v_smfmac_f32_32x32x32_bf16 v[88:103], v[32:35], v[56:63], v136
  v_exp_f32 v68, v68
  v_exp_f32 v69, v69
  v_exp_f32 v70, v70
  v_exp_f32 v71, v71
  v_add_u32 v137, 4096, v137
  v_add_u32 v138, 4096, v138
  s_add_u32 s44, s44, 1
  s_cmp_lt_u32 s44, 6
  s_cbranch_scc1 P2_loop_s
  s_nop 1
  v_smfmac_f32_32x32x32_bf16 v[88:103], v[36:39], v[64:71], v136
  s_branch P2_xch
P4_cs:
  s_lshl_b32 s25, s27, 2
  s_sub_u32 s29, s28, 28
  s_add_u32 s25, s25, s29
  s_barrier
  s_cmp_ge_u32 s25, 28
  s_cbranch_scc1 P4_join
  s_mov_b32 s12, s72
  s_and_b32 s13, s73, 0xffff
  s_mov_b32 s14, 1835008
  s_mov_b32 s15, 0x20000
  s_add_u32 s52, s84, 21037056
  s_addc_u32 s53, s85, 0
  s_and_b32 s53, s53, 0xffff
  s_mov_b32 s54, 7168
  s_mov_b32 s55, 0x20000
  v_lshrrev_b32 v2, 3, v1
  v_mul_u32_u24 v2, 3584, v2
  v_and_b32 v3, 7, v1
  v_lshl_add_u32 v2, v3, 4, v2
  s_mul_i32 s32, s24, 229376
  s_lshl_b32 s33, s25, 7
  s_add_u32 s32, s32, s33
  s_add_u32 s33, s32, 0
  buffer_load_dwordx4 v[64:67], v2, s[12:15], s33 offen
  s_add_u32 s33, s32, 28672
  buffer_load_dwordx4 v[68:71], v2, s[12:15], s33 offen
  s_add_u32 s33, s32, 57344
  buffer_load_dwordx4 v[72:75], v2, s[12:15], s33 offen
  s_add_u32 s33, s32, 86016
  buffer_load_dwordx4 v[76:79], v2, s[12:15], s33 offen
  s_add_u32 s33, s32, 114688
  buffer_load_dwordx4 v[80:83], v2, s[12:15], s33 offen
  s_add_u32 s33, s32, 143360
  buffer_load_dwordx4 v[84:87], v2, s[12:15], s33 offen
  s_add_u32 s33, s32, 172032
  buffer_load_dwordx4 v[88:91], v2, s[12:15], s33 offen
  s_add_u32 s33, s32, 200704
  buffer_load_dwordx4 v[92:95], v2, s[12:15], s33 offen
  v_mov_b32 v96, 0
  v_mov_b32 v97, 0
  v_mov_b32 v98, 0
  v_mov_b32 v99, 0
  v_mov_b32 v100, 0
  v_mov_b32 v101, 0
  v_mov_b32 v102, 0
  v_mov_b32 v103, 0
  s_waitcnt vmcnt(7)
  v_lshlrev_b32 v26, 16, v64
  v_and_b32 v27, 0xffff0000, v64
  v_pk_add_f32 v[96:97], v[96:97], v[26:27]
  v_lshlrev_b32 v28, 16, v65
  v_and_b32 v29, 0xffff0000, v65
  v_pk_add_f32 v[98:99], v[98:99], v[28:29]
  v_lshlrev_b32 v26, 16, v66
  v_and_b32 v27, 0xffff0000, v66
  v_pk_add_f32 v[100:101], v[100:101], v[26:27]
  v_lshlrev_b32 v28, 16, v67
  v_and_b32 v29, 0xffff0000, v67
  v_pk_add_f32 v[102:103], v[102:103], v[28:29]
  s_waitcnt vmcnt(6)
  v_lshlrev_b32 v26, 16, v68
  v_and_b32 v27, 0xffff0000, v68
  v_pk_add_f32 v[96:97], v[96:97], v[26:27]
  v_lshlrev_b32 v28, 16, v69
  v_and_b32 v29, 0xffff0000, v69
  v_pk_add_f32 v[98:99], v[98:99], v[28:29]
  v_lshlrev_b32 v26, 16, v70
  v_and_b32 v27, 0xffff0000, v70
  v_pk_add_f32 v[100:101], v[100:101], v[26:27]
  v_lshlrev_b32 v28, 16, v71
  v_and_b32 v29, 0xffff0000, v71
  v_pk_add_f32 v[102:103], v[102:103], v[28:29]
  s_waitcnt vmcnt(5)
  v_lshlrev_b32 v26, 16, v72
  v_and_b32 v27, 0xffff0000, v72
  v_pk_add_f32 v[96:97], v[96:97], v[26:27]
  v_lshlrev_b32 v28, 16, v73
  v_and_b32 v29, 0xffff0000, v73
  v_pk_add_f32 v[98:99], v[98:99], v[28:29]
  v_lshlrev_b32 v26, 16, v74
  v_and_b32 v27, 0xffff0000, v74
  v_pk_add_f32 v[100:101], v[100:101], v[26:27]
  v_lshlrev_b32 v28, 16, v75
  v_and_b32 v29, 0xffff0000, v75
  v_pk_add_f32 v[102:103], v[102:103], v[28:29]
  s_waitcnt vmcnt(4)
  v_lshlrev_b32 v26, 16, v76
  v_and_b32 v27, 0xffff0000, v76
  v_pk_add_f32 v[96:97], v[96:97], v[26:27]
  v_lshlrev_b32 v28, 16, v77
  v_and_b32 v29, 0xffff0000, v77
  v_pk_add_f32 v[98:99], v[98:99], v[28:29]
  v_lshlrev_b32 v26, 16, v78
  v_and_b32 v27, 0xffff0000, v78
  v_pk_add_f32 v[100:101], v[100:101], v[26:27]
  v_lshlrev_b32 v28, 16, v79
  v_and_b32 v29, 0xffff0000, v79
  v_pk_add_f32 v[102:103], v[102:103], v[28:29]
  s_waitcnt vmcnt(3)
  v_lshlrev_b32 v26, 16, v80
  v_and_b32 v27, 0xffff0000, v80
  v_pk_add_f32 v[96:97], v[96:97], v[26:27]
  v_lshlrev_b32 v28, 16, v81
  v_and_b32 v29, 0xffff0000, v81
  v_pk_add_f32 v[98:99], v[98:99], v[28:29]
  v_lshlrev_b32 v26, 16, v82
  v_and_b32 v27, 0xffff0000, v82
  v_pk_add_f32 v[100:101], v[100:101], v[26:27]
  v_lshlrev_b32 v28, 16, v83
  v_and_b32 v29, 0xffff0000, v83
  v_pk_add_f32 v[102:103], v[102:103], v[28:29]
  s_waitcnt vmcnt(2)
  v_lshlrev_b32 v26, 16, v84
  v_and_b32 v27, 0xffff0000, v84
  v_pk_add_f32 v[96:97], v[96:97], v[26:27]
  v_lshlrev_b32 v28, 16, v85
  v_and_b32 v29, 0xffff0000, v85
  v_pk_add_f32 v[98:99], v[98:99], v[28:29]
  v_lshlrev_b32 v26, 16, v86
  v_and_b32 v27, 0xffff0000, v86
  v_pk_add_f32 v[100:101], v[100:101], v[26:27]
  v_lshlrev_b32 v28, 16, v87
  v_and_b32 v29, 0xffff0000, v87
  v_pk_add_f32 v[102:103], v[102:103], v[28:29]
  s_waitcnt vmcnt(1)
  v_lshlrev_b32 v26, 16, v88
  v_and_b32 v27, 0xffff0000, v88
  v_pk_add_f32 v[96:97], v[96:97], v[26:27]
  v_lshlrev_b32 v28, 16, v89
  v_and_b32 v29, 0xffff0000, v89
  v_pk_add_f32 v[98:99], v[98:99], v[28:29]
  v_lshlrev_b32 v26, 16, v90
  v_and_b32 v27, 0xffff0000, v90
  v_pk_add_f32 v[100:101], v[100:101], v[26:27]
  v_lshlrev_b32 v28, 16, v91
  v_and_b32 v29, 0xffff0000, v91
  v_pk_add_f32 v[102:103], v[102:103], v[28:29]
  s_waitcnt vmcnt(0)
  v_lshlrev_b32 v26, 16, v92
  v_and_b32 v27, 0xffff0000, v92
  v_pk_add_f32 v[96:97], v[96:97], v[26:27]
  v_lshlrev_b32 v28, 16, v93
  v_and_b32 v29, 0xffff0000, v93
  v_pk_add_f32 v[98:99], v[98:99], v[28:29]
  v_lshlrev_b32 v26, 16, v94
  v_and_b32 v27, 0xffff0000, v94
  v_pk_add_f32 v[100:101], v[100:101], v[26:27]
  v_lshlrev_b32 v28, 16, v95
  v_and_b32 v29, 0xffff0000, v95
  v_pk_add_f32 v[102:103], v[102:103], v[28:29]
  s_nop 1
  v_add_f32_dpp v96, v96, v96 row_ror:8 row_mask:0xf bank_mask:0xf
  v_add_f32_dpp v97, v97, v97 row_ror:8 row_mask:0xf bank_mask:0xf
  v_add_f32_dpp v98, v98, v98 row_ror:8 row_mask:0xf bank_mask:0xf
  v_add_f32_dpp v99, v99, v99 row_ror:8 row_mask:0xf bank_mask:0xf
  v_add_f32_dpp v100, v100, v100 row_ror:8 row_mask:0xf bank_mask:0xf
  v_add_f32_dpp v101, v101, v101 row_ror:8 row_mask:0xf bank_mask:0xf
  v_add_f32_dpp v102, v102, v102 row_ror:8 row_mask:0xf bank_mask:0xf
  v_add_f32_dpp v103, v103, v103 row_ror:8 row_mask:0xf bank_mask:0xf
  v_mov_b32 v112, v96
  v_mov_b32 v113, v97
  v_mov_b32 v114, v98
  v_mov_b32 v115, v99
  v_mov_b32 v116, v100
  v_mov_b32 v117, v101
  v_mov_b32 v118, v102
  v_mov_b32 v119, v103
  v_permlane16_swap_b32 v96, v112
  v_permlane16_swap_b32 v97, v113
  v_permlane16_swap_b32 v98, v114
  v_permlane16_swap_b32 v99, v115
  v_permlane16_swap_b32 v100, v116
  v_permlane16_swap_b32 v101, v117
  v_permlane16_swap_b32 v102, v118
  v_permlane16_swap_b32 v103, v119
  v_add_f32 v96, v96, v112
  v_add_f32 v97, v97, v113
  v_add_f32 v98, v98, v114
  v_add_f32 v99, v99, v115
  v_add_f32 v100, v100, v116
  v_add_f32 v101, v101, v117
  v_add_f32 v102, v102, v118
  v_add_f32 v103, v103, v119
  v_mov_b32 v112, v96
  v_mov_b32 v113, v97
  v_mov_b32 v114, v98
  v_mov_b32 v115, v99
  v_mov_b32 v116, v100
  v_mov_b32 v117, v101
  v_mov_b32 v118, v102
  v_mov_b32 v119, v103
  v_permlane32_swap_b32 v96, v112
  v_permlane32_swap_b32 v97, v113
  v_permlane32_swap_b32 v98, v114
  v_permlane32_swap_b32 v99, v115
  v_permlane32_swap_b32 v100, v116
  v_permlane32_swap_b32 v101, v117
  v_permlane32_swap_b32 v102, v118
  v_permlane32_swap_b32 v103, v119
  v_add_f32 v96, v96, v112
  v_add_f32 v97, v97, v113
  v_add_f32 v98, v98, v114
  v_add_f32 v99, v99, v115
  v_add_f32 v100, v100, v116
  v_add_f32 v101, v101, v117
  v_add_f32 v102, v102, v118
  v_add_f32 v103, v103, v119
  v_lshlrev_b32 v20, 5, v1
  s_lshl_b32 s39, s24, 8
  v_add_u32 v20, s39, v20
  s_mov_b64 exec, 0xff
  ds_write_b128 v20, v[96:99]
  ds_write_b128 v20, v[100:103] offset:16
  s_mov_b64 exec, -1
  s_waitcnt lgkmcnt(0)
  s_barrier
  s_cmp_lg_u32 s24, 0
  s_cbranch_scc1 P4csw_L_900001
  v_lshlrev_b32 v20, 2, v1
  ds_read_b32 v64, v20 offset:0
  ds_read_b32 v65, v20 offset:256
  ds_read_b32 v66, v20 offset:512
  ds_read_b32 v67, v20 offset:768
  ds_read_b32 v68, v20 offset:1024
  ds_read_b32 v69, v20 offset:1280
  ds_read_b32 v70, v20 offset:1536
  ds_read_b32 v71, v20 offset:1792
  s_waitcnt lgkmcnt(0)
  v_add_f32 v64, v64, v65
  v_add_f32 v64, v64, v66
  v_add_f32 v64, v64, v67
  v_add_f32 v64, v64, v68
  v_add_f32 v64, v64, v69
  v_add_f32 v64, v64, v70
  v_add_f32 v64, v64, v71
  s_lshl_b32 s33, s25, 8
  buffer_store_dword v64, v20, s[52:55], s33 offen sc1
  s_add_u32 s48, s84, 23068672
  s_addc_u32 s49, s85, 0
  s_and_b32 s49, s49, 0xffff
  s_mov_b32 s50, 135168
  s_mov_b32 s51, 0x20000
  s_add_u32 s46, s25, 1024
  s_lshl_b32 s46, s46, 7
  v_mov_b32 v250, 163792
  v_mov_b32 v251, 1
  v_mov_b32 v253, s86
  v_mov_b32 v254, 0
  s_waitcnt vmcnt(0)
  s_mov_b64 exec, 1
  ds_add_rtn_u32 v251, v250, v251
  s_waitcnt lgkmcnt(0)
  v_readfirstlane_b32 s47, v251
  s_nop 3
  s_cmp_lg_u32 s47, 0
  s_cbranch_scc1 P4_arr_L_900002
  buffer_store_dword v253, v254, s[48:51], s46 offen sc1
P4_arr_L_900002:
  s_mov_b64 exec, -1
P4csw_L_900001:
  s_barrier
  s_branch P4_join
E_end:
  s_endpgm
.section .rodata,"a"
.p2align 6
.amdhsa_kernel sequential_preLN__softmax_full_mha__dense_activation_gelu__prompt_kernel
  .amdhsa_next_free_vgpr 256
  .amdhsa_next_free_sgpr 100
  .amdhsa_accum_offset 256
  .amdhsa_group_segment_fixed_size 0
  .amdhsa_kernarg_size 88
  .amdhsa_user_sgpr_count 2
  .amdhsa_user_sgpr_kernarg_segment_ptr 1
  .amdhsa_system_sgpr_workgroup_id_x 1
  .amdhsa_float_denorm_mode_32 3
  .amdhsa_float_denorm_mode_16_64 3
.end_amdhsa_kernel
```
